```python
import torch

def _softmax(x, axis=-1):
    return torch.softmax(x, dim=axis)
def _gelu(x):
    return torch.nn.functional.gelu(x, approximate="tanh")
def _silu(x):
    return torch.nn.functional.silu(x)
def _sigmoid(x):
    return torch.sigmoid(x)
def _layernorm(x, axis=-1, eps=1e-5):
    m = x.mean(dim=axis, keepdim=True)
    v = x.var(dim=axis, keepdim=True, unbiased=False)
    return (x - m) / torch.sqrt(v + eps)
def _scatter_add(tgt, idx, src, axis=0):
    return tgt.clone().index_add_(axis, idx, src)
def _segment_sum(src, seg, n):
    out = torch.zeros((n,) + src.shape[1:], dtype=src.dtype)
    return out.index_add_(0, seg, src)
def _pad(x, pw):
    flat = tuple(v for pair in reversed(pw) for v in pair)
    return torch.nn.functional.pad(x, flat)

kernel_name = 'parallel_sum__compressed_kv_cla__glu_gated_swiglu__decode'

def setup_inputs():

    _w = (lambda a: (lambda t: t.to(torch.bfloat16) if t.is_floating_point() else t)(torch.as_tensor(a)))
    def _A_setup():
        B, H, Sq, Sk, D, M = 2, 32, 1, 8192, 128, 512
        Dc = 4 * D
        return {
            "x": _w((lambda *s: torch.randn(*s, dtype=torch.bfloat16) * 0.05)(B, Sq, M)),
            "c_kv": _w((lambda *s: torch.randn(*s, dtype=torch.bfloat16) * 0.8)(B, Sk, Dc)),
            "w_q": _w((lambda *s: torch.randn(*s, dtype=torch.bfloat16) * 1.6)(M, H, D) * (M ** -0.5)),
            "w_uk": _w((lambda *s: torch.randn(*s, dtype=torch.bfloat16) * 1.6)(Dc, H, D) * (Dc ** -0.5)),
            "w_uv": _w((lambda *s: torch.randn(*s, dtype=torch.bfloat16) * 0.8)(Dc, H, D) * (Dc ** -0.5)),
            "w_o": _w((lambda *s: torch.randn(*s, dtype=torch.bfloat16) * 0.8)(H, D, M) * ((H * D) ** -0.5)),
        }
    _A_in = _A_setup()

    def _B_setup():
        B, S, D, F = 2, 1, 512, 1376
        return {
            "x": _w((lambda *s: torch.randn(*s, dtype=torch.bfloat16) * 0.05)(B, S, D)),
            "w1": _w((lambda *s: torch.randn(*s, dtype=torch.bfloat16) * 0.2)(D, F) * (2.0 / D) ** 0.5),
            "w3": _w((lambda *s: torch.randn(*s, dtype=torch.bfloat16) * 0.2)(D, F) * (2.0 / D) ** 0.5),
            "w2": _w((lambda *s: torch.randn(*s, dtype=torch.bfloat16) * 0.2)(F, D) * (2.0 / F) ** 0.5),
        }
    _B_in = _B_setup()

    return {
        "A_x": _A_in["x"],
        "A_c_kv": _A_in["c_kv"],
        "A_w_q": _A_in["w_q"],
        "A_w_uk": _A_in["w_uk"],
        "A_w_uv": _A_in["w_uv"],
        "A_w_o": _A_in["w_o"],
        "B_x": _B_in["x"],
        "B_w1": _B_in["w1"],
        "B_w3": _B_in["w3"],
        "B_w2": _B_in["w2"],
    }

def reference(A_x, A_c_kv, A_w_q, A_w_uk, A_w_uv, A_w_o, B_x, B_w1, B_w3, B_w2):
    def _A_ref(x, c_kv, w_q, w_uk, w_uv, w_o):
        B, Sq, M = x.shape[0], x.shape[1], x.shape[2]
        Sk = c_kv.shape[1]
        H, D = w_q.shape[1], w_q.shape[2]
        q = torch.einsum("bqm,mhd->bhqd", x, w_q)
        k = torch.einsum("bkc,chd->bhkd", c_kv, w_uk)
        v = torch.einsum("bkc,chd->bhkd", c_kv, w_uv)
        scores = torch.einsum("bhqd,bhkd->bhqk", q, k) * (D ** -0.5)
        off = Sk - Sq
        qi = torch.arange(Sq)[:, None]
        kj = torch.arange(Sk)[None, :]
        cmask = kj <= (qi + off)
        scores = torch.where(cmask[None, None], scores, -1e9)
        p = _softmax(scores, axis=-1)
        ctx = torch.einsum("bhqk,bhkd->bhqd", p, v)
        return torch.einsum("bhqd,hdm->bqm", ctx, w_o)

    def _B_ref(x, w1, w3, w2):
        gate = torch.einsum("bsd,df->bsf", x, w1)
        up = torch.einsum("bsd,df->bsf", x, w3)
        h = _silu(gate) * up
        out = torch.einsum("bsf,fd->bsd", h, w2)
        return out

    x = A_x
    xn = _layernorm(x, axis=-1)
    return x + _A_ref(xn, A_c_kv, A_w_q, A_w_uk, A_w_uv, A_w_o) + _B_ref(xn, B_w1, B_w3, B_w2)
```

```asm
; @launch grid=(256,1,1) block=(512,1,1) lds=163328
.amdgcn_target "amdgcn-amd-amdhsa--gfx950"
.text
.globl parallel_sum__compressed_kv_cla__glu_gated_swiglu__decode_kernel
.p2align 8
.type parallel_sum__compressed_kv_cla__glu_gated_swiglu__decode_kernel,@function
parallel_sum__compressed_kv_cla__glu_gated_swiglu__decode_kernel:
    s_cmp_ge_u32 s2, 256
    s_cbranch_scc1 L_exit
    s_load_dwordx16 s[68:83], s[0:1], 0
    s_getpc_b64 s[4:5]
L_pc:
    .set CODE_PIECES, (L_exit - L_pc + 1023) / 1024
    s_lshr_b32 s6, s2, 3
    s_min_u32 s6, s6, CODE_PIECES - 1
    s_lshl_b32 s6, s6, 10
    s_add_u32 s4, s4, s6
    s_addc_u32 s5, s5, 0
    v_lshrrev_b32 v7, 6, v0
    v_lshlrev_b32 v7, 7, v7
    v_and_b32 v8, 7, v0
    v_lshl_add_u32 v7, v8, 4, v7
    s_mov_b64 exec, 0xff
    global_load_dwordx4 v[252:255], v7, s[4:5]
    s_mov_b64 exec, -1
    s_load_dwordx8 s[84:91], s[0:1], 64
    s_load_dwordx2 s[92:93], s[0:1], 96
    v_and_b32 v1, 63, v0
    v_lshrrev_b32 v7, 6, v0
    v_and_b32 v2, 15, v0
    v_readfirstlane_b32 s3, v7
    v_lshrrev_b32 v3, 4, v1
    v_mov_b32 v5, 0
    v_lshlrev_b32 v6, 4, v1
    v_mov_b32 v10, 148480
    v_mov_b32 v11, 1
    v_lshlrev_b32 v7, 1, v3
    v_xor_b32 v7, v2, v7
    v_lshlrev_b32 v7, 4, v7
    v_lshl_add_u32 v7, v3, 13, v7
    v_xor_b32 v8, 128, v7
    s_and_b32 s56, s2, 7
    s_lshr_b32 s57, s2, 6
    s_lshr_b32 s58, s2, 3
    s_and_b32 s58, s58, 7
    s_and_b32 s4, s57, 1
    s_xor_b32 s60, s4, 1
    s_lshr_b32 s61, s57, 1
    s_lshl_b32 s59, s4, 4
    s_lshl_b32 s5, s56, 1
    s_add_u32 s59, s59, s5
    s_add_u32 s59, s59, s61
    s_lshl_b32 s62, s58, 3
    s_add_u32 s62, s62, s56
    s_lshl_b32 s64, s57, 3
    s_add_u32 s64, s64, s56
    s_cmp_lt_u32 s64, 22
    s_cselect_b32 s65, 1, 0
    s_and_b32 s66, s3, 3
    s_mov_b32 s67, 0xffff0000
    s_mov_b32 s99, 0
    s_waitcnt lgkmcnt(0)
    s_mov_b32 s44, s68
    s_and_b32 s45, s69, 0xffff
    s_mov_b32 s46, 2048
    s_mov_b32 s47, 0x20000
    s_mov_b32 s12, s72
    s_and_b32 s13, s73, 0xffff
    s_mov_b32 s14, 4194304
    s_mov_b32 s15, 0x20000
    s_cmp_ge_u32 s3, 4
    s_cbranch_scc1 L_shead0
    buffer_load_dwordx4 v[16:19], v6, s[44:47], 0 offen
    buffer_load_dwordx4 v[20:23], v6, s[44:47], 0 offen offset:1024
    s_lshl_b32 s68, s58, 6
    s_lshl_b32 s69, s66, 4
    s_add_u32 s68, s68, s69
    s_lshl_b32 s68, s68, 13
    s_lshl_b32 s69, s59, 8
    s_add_u32 s4, s68, s69
    s_lshl_b32 s6, s66, 12
    s_add_u32 m0, s6, 131072
    s_add_u32 s5, s4, 0
    buffer_load_dwordx4 v7, s[12:15], s5 offen nt lds
    s_add_u32 m0, s6, 132096
    s_add_u32 s5, s4, 32768
    buffer_load_dwordx4 v8, s[12:15], s5 offen nt lds
    s_add_u32 m0, s6, 133120
    s_add_u32 s5, s4, 65536
    buffer_load_dwordx4 v7, s[12:15], s5 offen nt lds
    s_add_u32 m0, s6, 134144
    s_add_u32 s5, s4, 98304
    buffer_load_dwordx4 v8, s[12:15], s5 offen nt lds
    v_lshlrev_b32 v9, 1, v1
    s_lshl_b32 s5, s58, 7
    buffer_load_ushort v24, v9, s[44:47], s5 offen
    buffer_load_ushort v25, v9, s[44:47], s5 offen offset:1024
    s_mov_b32 s16, s74
    s_and_b32 s17, s75, 0xffff
    s_mov_b32 s18, 4194304
    s_mov_b32 s19, 0x20000
L_shead0:
    s_mov_b32 s40, s92
    s_and_b32 s41, s93, 0xffff
    s_mov_b32 s42, 268435456
    s_mov_b32 s43, 0x20000
    s_add_u32 s6, s92, 0
    s_addc_u32 s7, s93, 0
    s_load_dword s63, s[6:7], 0
    s_mov_b32 s8, s70
    s_and_b32 s9, s71, 0xffff
    s_mov_b32 s10, 16777216
    s_mov_b32 s11, 0x20000
    s_mov_b32 s16, s74
    s_and_b32 s17, s75, 0xffff
    s_mov_b32 s18, 4194304
    s_mov_b32 s19, 0x20000
    s_mov_b32 s20, s76
    s_and_b32 s21, s77, 0xffff
    s_mov_b32 s22, 4194304
    s_mov_b32 s23, 0x20000
    s_mov_b32 s24, s78
    s_and_b32 s25, s79, 0xffff
    s_mov_b32 s26, 4194304
    s_mov_b32 s27, 0x20000
    s_mov_b32 s28, s82
    s_and_b32 s29, s83, 0xffff
    s_mov_b32 s30, 1409024
    s_mov_b32 s31, 0x20000
    s_mov_b32 s32, s84
    s_and_b32 s33, s85, 0xffff
    s_mov_b32 s34, 1409024
    s_mov_b32 s35, 0x20000
    s_mov_b32 s36, s86
    s_and_b32 s37, s87, 0xffff
    s_mov_b32 s38, 1409024
    s_mov_b32 s39, 0x20000
    s_mov_b32 s48, s88
    s_and_b32 s49, s89, 0xffff
    s_mov_b32 s50, 2048
    s_mov_b32 s51, 0x20000
    s_mov_b32 s52, s90
    s_and_b32 s53, s91, 0xffff
    s_mov_b32 s54, 256
    s_mov_b32 s55, 0x20000
    s_lshl_b32 s72, s59, 3
    s_add_u32 s72, s72, s58
    s_mov_b64 exec, 0xffff
    v_lshl_add_u32 v9, v1, 2, v10
    ds_write_b32 v9, v5
    s_mov_b64 exec, -1
    s_waitcnt lgkmcnt(0)
    s_barrier
    s_mul_i32 s63, s63, 0x9E3779B1
    s_add_u32 s63, s63, 0x7F4A7C15
    v_mov_b32 v4, s63
    s_cmp_ge_u32 s3, 4
    s_cbranch_scc1 L_shead
    v_lshrrev_b32 v196, 2, v2
    v_lshl_add_u32 v196, v3, 3, v196
    v_and_b32 v197, 1, v2
    v_lshlrev_b32 v197, 3, v197
    v_bfe_u32 v198, v2, 1, 1
    v_mov_b32 v70, v196
    v_mov_b32 v71, v197
    v_mov_b32 v72, v198
    v_lshlrev_b32 v74, 4, v3
    v_lshrrev_b32 v13, 3, v1
    v_lshlrev_b32 v12, 10, v13
    v_and_b32 v196, 7, v1
    v_lshl_add_u32 v12, v196, 4, v12
    v_lshlrev_b32 v13, 9, v13
    s_waitcnt vmcnt(7)
    s_waitcnt vmcnt(6)
    v_lshlrev_b32 v84, 16, v16
    v_lshlrev_b32 v85, 16, v20
    v_and_b32 v86, s67, v16
    v_and_b32 v87, s67, v20
    v_lshlrev_b32 v88, 16, v17
    v_lshlrev_b32 v89, 16, v21
    v_and_b32 v90, s67, v17
    v_and_b32 v91, s67, v21
    v_lshlrev_b32 v92, 16, v18
    v_lshlrev_b32 v93, 16, v22
    v_and_b32 v94, s67, v18
    v_and_b32 v95, s67, v22
    v_lshlrev_b32 v96, 16, v19
    v_lshlrev_b32 v97, 16, v23
    v_and_b32 v98, s67, v19
    v_and_b32 v99, s67, v23
    v_pk_add_f32 v[100:101], v[84:85], v[86:87]
    v_pk_add_f32 v[102:103], v[88:89], v[90:91]
    v_pk_add_f32 v[104:105], v[92:93], v[94:95]
    v_pk_add_f32 v[106:107], v[96:97], v[98:99]
    v_pk_add_f32 v[100:101], v[100:101], v[102:103]
    v_pk_add_f32 v[104:105], v[104:105], v[106:107]
    v_pk_add_f32 v[100:101], v[100:101], v[104:105]
    s_nop 1
    v_add_f32_dpp v100, v100, v100 row_ror:8 row_mask:0xf bank_mask:0xf
    v_add_f32_dpp v101, v101, v101 row_ror:8 row_mask:0xf bank_mask:0xf
    s_nop 0
    v_add_f32_dpp v100, v100, v100 row_ror:4 row_mask:0xf bank_mask:0xf
    v_add_f32_dpp v101, v101, v101 row_ror:4 row_mask:0xf bank_mask:0xf
    s_nop 0
    v_add_f32_dpp v100, v100, v100 row_ror:2 row_mask:0xf bank_mask:0xf
    v_add_f32_dpp v101, v101, v101 row_ror:2 row_mask:0xf bank_mask:0xf
    s_nop 0
    v_add_f32_dpp v100, v100, v100 row_ror:1 row_mask:0xf bank_mask:0xf
    v_add_f32_dpp v101, v101, v101 row_ror:1 row_mask:0xf bank_mask:0xf
    v_mov_b32 v102, v100
    v_mov_b32 v103, v101
    s_nop 0
    v_permlane16_swap_b32 v100, v102
    v_permlane16_swap_b32 v101, v103
    v_add_f32 v100, v100, v102
    v_add_f32 v101, v101, v103
    v_mov_b32 v102, v100
    v_mov_b32 v103, v101
    s_nop 0
    v_permlane32_swap_b32 v100, v102
    v_permlane32_swap_b32 v101, v103
    v_add_f32 v100, v100, v102
    v_add_f32 v101, v101, v103
    s_mov_b32 s69, 0x3b000000
    v_mul_f32 v100, s69, v100
    v_mul_f32 v101, s69, v101
    v_pk_add_f32 v[84:85], v[84:85], v[100:101] neg_lo:[0,1] neg_hi:[0,1]
    v_pk_add_f32 v[86:87], v[86:87], v[100:101] neg_lo:[0,1] neg_hi:[0,1]
    v_pk_add_f32 v[88:89], v[88:89], v[100:101] neg_lo:[0,1] neg_hi:[0,1]
    v_pk_add_f32 v[90:91], v[90:91], v[100:101] neg_lo:[0,1] neg_hi:[0,1]
    v_pk_add_f32 v[92:93], v[92:93], v[100:101] neg_lo:[0,1] neg_hi:[0,1]
    v_pk_add_f32 v[94:95], v[94:95], v[100:101] neg_lo:[0,1] neg_hi:[0,1]
    v_pk_add_f32 v[96:97], v[96:97], v[100:101] neg_lo:[0,1] neg_hi:[0,1]
    v_pk_add_f32 v[98:99], v[98:99], v[100:101] neg_lo:[0,1] neg_hi:[0,1]
    v_pk_mul_f32 v[104:105], v[84:85], v[84:85]
    v_pk_mul_f32 v[106:107], v[86:87], v[86:87]
    v_pk_fma_f32 v[104:105], v[88:89], v[88:89], v[104:105]
    v_pk_fma_f32 v[106:107], v[90:91], v[90:91], v[106:107]
    v_pk_fma_f32 v[104:105], v[92:93], v[92:93], v[104:105]
    v_pk_fma_f32 v[106:107], v[94:95], v[94:95], v[106:107]
    v_pk_fma_f32 v[104:105], v[96:97], v[96:97], v[104:105]
    v_pk_fma_f32 v[106:107], v[98:99], v[98:99], v[106:107]
    v_pk_add_f32 v[104:105], v[104:105], v[106:107]
    s_nop 1
    v_add_f32_dpp v104, v104, v104 row_ror:8 row_mask:0xf bank_mask:0xf
    v_add_f32_dpp v105, v105, v105 row_ror:8 row_mask:0xf bank_mask:0xf
    s_nop 0
    v_add_f32_dpp v104, v104, v104 row_ror:4 row_mask:0xf bank_mask:0xf
    v_add_f32_dpp v105, v105, v105 row_ror:4 row_mask:0xf bank_mask:0xf
    s_nop 0
    v_add_f32_dpp v104, v104, v104 row_ror:2 row_mask:0xf bank_mask:0xf
    v_add_f32_dpp v105, v105, v105 row_ror:2 row_mask:0xf bank_mask:0xf
    s_nop 0
    v_add_f32_dpp v104, v104, v104 row_ror:1 row_mask:0xf bank_mask:0xf
    v_add_f32_dpp v105, v105, v105 row_ror:1 row_mask:0xf bank_mask:0xf
    v_mov_b32 v106, v104
    v_mov_b32 v107, v105
    s_nop 0
    v_permlane16_swap_b32 v104, v106
    v_permlane16_swap_b32 v105, v107
    v_add_f32 v104, v104, v106
    v_add_f32 v105, v105, v107
    v_mov_b32 v106, v104
    v_mov_b32 v107, v105
    s_nop 0
    v_permlane32_swap_b32 v104, v106
    v_permlane32_swap_b32 v105, v107
    v_add_f32 v104, v104, v106
    v_add_f32 v105, v105, v107
    v_mul_f32 v104, s69, v104
    v_mul_f32 v105, s69, v105
    v_cvt_pk_bf16_f32 v106, v100, v101
    v_and_b32 v101, s67, v106
    v_lshlrev_b32 v100, 16, v106
    v_cvt_pk_bf16_f32 v107, v104, v105
    v_and_b32 v105, s67, v107
    v_lshlrev_b32 v104, 16, v107
    s_mov_b32 s69, 0x3727c5ac
    v_add_f32 v104, s69, v104
    v_add_f32 v105, s69, v105
    v_cvt_pk_bf16_f32 v106, v104, v105
    v_and_b32 v105, s67, v106
    v_lshlrev_b32 v104, 16, v106
    v_sqrt_f32 v104, v104
    v_sqrt_f32 v105, v105
    s_nop 0
    v_cvt_pk_bf16_f32 v106, v104, v105
    v_and_b32 v105, s67, v106
    v_lshlrev_b32 v104, 16, v106
    v_rcp_f32 v104, v104
    v_rcp_f32 v105, v105
    s_waitcnt vmcnt(0)
    v_lshlrev_b32 v24, 16, v24
    v_lshlrev_b32 v25, 16, v25
    v_sub_f32 v24, v24, v100
    v_sub_f32 v25, v25, v101
    v_cvt_pk_bf16_f32 v106, v24, v25
    v_and_b32 v25, s67, v106
    v_lshlrev_b32 v24, 16, v106
    v_mul_f32 v24, v24, v104
    v_mul_f32 v25, v25, v105
    v_cvt_pk_bf16_f32 v24, v24, v25
    v_lshlrev_b32 v9, 1, v1
    v_add_u32 v9, 150656, v9
    ds_write_b16 v9, v24
    ds_write_b16_d16_hi v9, v24 offset:128
    s_mov_b64 exec, 1
    ds_add_u32 v10, v11 offset:16
    s_mov_b64 exec, -1
    s_lshl_b32 s84, s66, 1
    s_mov_b32 s68, 131072
    v_add_u32 v196, 0, v70
    v_and_b32 v197, 7, v196
    v_lshlrev_b32 v197, 1, v197
    s_lshl_b32 s69, s84, 1
    v_add_u32 v198, s69, v72
    v_xor_b32 v198, v198, v197
    v_lshlrev_b32 v196, 8, v196
    v_lshl_add_u32 v76, v198, 4, v196
    v_add_u32 v76, v76, v71
    v_add_u32 v76, s68, v76
    v_add_u32 v196, 4, v70
    v_and_b32 v197, 7, v196
    v_lshlrev_b32 v197, 1, v197
    s_lshl_b32 s69, s84, 1
    v_add_u32 v198, s69, v72
    v_xor_b32 v198, v198, v197
    v_lshlrev_b32 v196, 8, v196
    v_lshl_add_u32 v77, v198, 4, v196
    v_add_u32 v77, v77, v71
    v_add_u32 v77, s68, v77
    s_add_u32 s84, s84, 1
    v_add_u32 v196, 0, v70
    v_and_b32 v197, 7, v196
    v_lshlrev_b32 v197, 1, v197
    s_lshl_b32 s69, s84, 1
    v_add_u32 v198, s69, v72
    v_xor_b32 v198, v198, v197
    v_lshlrev_b32 v196, 8, v196
    v_lshl_add_u32 v79, v198, 4, v196
    v_add_u32 v79, v79, v71
    v_add_u32 v79, s68, v79
    v_add_u32 v196, 4, v70
    v_and_b32 v197, 7, v196
    v_lshlrev_b32 v197, 1, v197
    s_lshl_b32 s69, s84, 1
    v_add_u32 v198, s69, v72
    v_xor_b32 v198, v198, v197
    v_lshlrev_b32 v196, 8, v196
    v_lshl_add_u32 v80, v198, 4, v196
    v_add_u32 v80, v80, v71
    v_add_u32 v80, s68, v80
    v_and_b32 v78, 1, v1
    v_lshl_add_u32 v78, v78, 7, v74
    v_add_u32 v78, 150656, v78
    s_lshl_b32 s86, s72, 10
    s_lshl_b32 s69, s66, 8
    s_add_u32 s86, s86, s69
    s_add_u32 s86, s86, 65536
    s_lshl_b32 s87, s72, 9
    s_lshl_b32 s69, s66, 7
    s_add_u32 s87, s87, s69
    s_add_u32 s87, s87, 393216
    s_add_u32 s88, s86, 128
    s_add_u32 s89, s87, 64
Lw_1:
    ds_read_b32 v196, v10 offset:16
    s_waitcnt lgkmcnt(0)
    v_readfirstlane_b32 s71, v196
    s_nop 0
    s_cmp_lt_u32 s71, 4
    s_cbranch_scc1 Lw_1
    ds_read_b128 v[32:35], v78 offset:0
    ds_read_b64_tr_b16 v[48:49], v76 offset:0
    ds_read_b64_tr_b16 v[50:51], v77 offset:0
    ds_read_b128 v[36:39], v78 offset:64
    ds_read_b64_tr_b16 v[52:53], v76 offset:8192
    ds_read_b64_tr_b16 v[54:55], v77 offset:8192
    s_waitcnt lgkmcnt(3)
    v_mfma_f32_16x16x32_bf16 v[64:67], v[32:35], v[48:51], 0
    s_waitcnt lgkmcnt(0)
    v_mfma_f32_16x16x32_bf16 v[64:67], v[36:39], v[52:55], v[64:67]
    s_nop 7
    v_add_u32 v196, v64, v65
    v_lshlrev_b32 v197, 3, v2
    v_add_u32 v81, s86, v197
    v_and_b32 v197, 0x38, v197
    v_add_u32 v197, s87, v197
    v_add_u32_dpp v196, v196, v196 row_ror:8 row_mask:0xf bank_mask:0xf
    s_nop 1
    v_add_u32_dpp v196, v196, v196 row_ror:4 row_mask:0xf bank_mask:0xf
    s_nop 1
    v_add_u32_dpp v196, v196, v196 row_ror:2 row_mask:0xf bank_mask:0xf
    s_nop 1
    v_add_u32_dpp v196, v196, v196 row_ror:1 row_mask:0xf bank_mask:0xf
    v_cmp_gt_u32 vcc, 16, v1
    v_add_u32 v196, v196, v4
    s_nop 0
    v_cndmask_b32 v81, v197, v81, vcc
    v_cndmask_b32 v68, v196, v64, vcc
    v_cndmask_b32 v69, v196, v65, vcc
    s_mov_b64 exec, 0xffffff
    s_mov_b32 s71, 8388608
    buffer_store_dwordx2 v[68:69], v81, s[40:43], s71 offen
    s_mov_b64 exec, -1
    ds_read_b128 v[32:35], v78 offset:0
    ds_read_b64_tr_b16 v[48:49], v79 offset:0
    ds_read_b64_tr_b16 v[50:51], v80 offset:0
    ds_read_b128 v[36:39], v78 offset:64
    ds_read_b64_tr_b16 v[52:53], v79 offset:8192
    ds_read_b64_tr_b16 v[54:55], v80 offset:8192
    s_waitcnt lgkmcnt(3)
    v_mfma_f32_16x16x32_bf16 v[64:67], v[32:35], v[48:51], 0
    s_waitcnt lgkmcnt(0)
    v_mfma_f32_16x16x32_bf16 v[64:67], v[36:39], v[52:55], v[64:67]
    s_nop 7
    v_add_u32 v196, v64, v65
    v_lshlrev_b32 v197, 3, v2
    v_add_u32 v92, s88, v197
    v_and_b32 v197, 0x38, v197
    v_add_u32 v197, s89, v197
    v_add_u32_dpp v196, v196, v196 row_ror:8 row_mask:0xf bank_mask:0xf
    s_nop 1
    v_add_u32_dpp v196, v196, v196 row_ror:4 row_mask:0xf bank_mask:0xf
    s_nop 1
    v_add_u32_dpp v196, v196, v196 row_ror:2 row_mask:0xf bank_mask:0xf
    s_nop 1
    v_add_u32_dpp v196, v196, v196 row_ror:1 row_mask:0xf bank_mask:0xf
    v_cmp_gt_u32 vcc, 16, v1
    v_add_u32 v196, v196, v4
    s_nop 0
    v_cndmask_b32 v92, v197, v92, vcc
    v_cndmask_b32 v82, v196, v64, vcc
    v_cndmask_b32 v83, v196, v65, vcc
    s_mov_b64 exec, 0xffffff
    s_mov_b32 s71, 8388608
    buffer_store_dwordx2 v[82:83], v92, s[40:43], s71 offen
    s_mov_b64 exec, -1
    v_and_b32 v196, 7, v1
    v_lshlrev_b32 v196, 1, v196
    s_lshl_b32 s69, s66, 12
    s_add_u32 s69, s69, 114688
    v_lshlrev_b32 v197, 8, v2
    v_add_u32 v198, 0, v3
    v_xor_b32 v198, v198, v196
    v_lshl_add_u32 v198, v198, 4, v197
    v_add_u32 v88, s69, v198
    v_add_u32 v198, 4, v3
    v_xor_b32 v198, v198, v196
    v_lshl_add_u32 v198, v198, 4, v197
    v_add_u32 v89, s69, v198
    v_add_u32 v198, 8, v3
    v_xor_b32 v198, v198, v196
    v_lshl_add_u32 v198, v198, 4, v197
    v_add_u32 v90, s69, v198
    v_add_u32 v198, 12, v3
    v_xor_b32 v198, v198, v196
    v_lshl_add_u32 v198, v198, 4, v197
    v_add_u32 v91, s69, v198
    v_and_b32 v78, 1, v1
    v_lshl_add_u32 v78, v78, 8, v74
    v_add_u32 v78, 147968, v78
    v_lshrrev_b32 v204, 2, v2
    v_lshl_add_u32 v204, v3, 2, v204
    v_and_b32 v205, 7, v204
    v_lshlrev_b32 v205, 1, v205
    v_lshlrev_b32 v204, 10, v204
    v_and_b32 v206, 1, v2
    v_lshl_add_u32 v204, v206, 3, v204
    v_bfe_u32 v206, v2, 1, 1
    s_lshl_b32 s69, s3, 3
    v_add_u32 v206, s69, v206
    v_add_u32 v207, 0, v206
    v_xor_b32 v207, v207, v205
    v_lshl_add_u32 v208, v207, 4, v204
    v_add_u32 v212, 65536, v208
    v_add_u32 v207, 2, v206
    v_xor_b32 v207, v207, v205
    v_lshl_add_u32 v209, v207, 4, v204
    v_add_u32 v213, 65536, v209
    v_add_u32 v207, 4, v206
    v_xor_b32 v207, v207, v205
    v_lshl_add_u32 v210, v207, 4, v204
    v_add_u32 v214, 65536, v210
    v_add_u32 v207, 6, v206
    v_xor_b32 v207, v207, v205
    v_lshl_add_u32 v211, v207, 4, v204
    v_add_u32 v215, 65536, v211
    v_lshrrev_b32 v204, 3, v1
    v_bfe_u32 v205, v1, 4, 2
    v_lshlrev_b32 v205, 1, v205
    v_and_b32 v206, 7, v1
    v_xor_b32 v206, v206, v205
    v_lshlrev_b32 v206, 4, v206
    v_lshl_add_u32 v216, v204, 10, v206
    v_lshl_add_u32 v220, v204, 7, v206
    v_mul_u32_u24 v219, 2752, v204
    v_add_u32 v219, v219, v206
    v_lshlrev_b32 v205, 1, v3
    v_xor_b32 v206, v2, v205
    v_lshlrev_b32 v206, 4, v206
    v_lshl_add_u32 v217, v3, 13, v206
    v_xor_b32 v218, 128, v217
    s_lshl_b32 s68, s58, 6
    s_lshl_b32 s69, s66, 4
    s_add_u32 s68, s68, s69
    s_lshl_b32 s69, s68, 13
    s_lshl_b32 s70, s59, 8
    s_add_u32 s80, s69, s70
    s_lshl_b32 s70, s58, 7
    s_lshl_b32 s82, s59, 7
    s_lshl_b32 s71, s3, 4
    s_add_u32 s82, s82, s71
    s_lshl_b32 s82, s82, 10
    s_add_u32 s82, s82, s70
    s_lshl_b32 s68, s58, 6
    s_lshl_b32 s69, s66, 4
    s_add_u32 s68, s68, s69
    s_mul_i32 s81, s68, 2752
    s_lshl_b32 s69, s64, 7
    s_add_u32 s81, s81, s69
    s_lshl_b32 s83, s64, 6
    s_lshl_b32 s71, s3, 3
    s_add_u32 s83, s83, s71
    s_lshl_b32 s83, s83, 10
    s_add_u32 s83, s83, s70
    s_lshl_b32 s90, s66, 1
    s_mov_b32 s98, 0
    s_cmp_lt_u32 s98, 12
    s_cselect_b32 s4, 8388608, 0
    s_add_u32 s5, s90, 0
    s_lshl_b32 s6, s59, 13
    s_lshl_b32 s7, s5, 7
    s_add_u32 s6, s6, s7
    s_add_u32 s6, s6, s4
    s_add_u32 s6, s6, 65536
    s_lshl_b32 s7, s59, 12
    s_lshl_b32 s5, s5, 6
    s_add_u32 s7, s7, s5
    s_add_u32 s7, s7, s4
    s_add_u32 s7, s7, 393216
    buffer_load_dwordx4 v[16:19], v12, s[40:43], s6 offen sc1
    buffer_load_dword v24, v13, s[40:43], s7 offen sc1
    s_cmp_lt_u32 s98, 12
    s_cselect_b32 s4, 8388608, 0
    s_add_u32 s5, s90, 1
    s_lshl_b32 s6, s59, 13
    s_lshl_b32 s7, s5, 7
    s_add_u32 s6, s6, s7
    s_add_u32 s6, s6, s4
    s_add_u32 s6, s6, 65536
    s_lshl_b32 s7, s59, 12
    s_lshl_b32 s5, s5, 6
    s_add_u32 s7, s7, s5
    s_add_u32 s7, s7, s4
    s_add_u32 s7, s7, 393216
    buffer_load_dwordx4 v[20:23], v12, s[40:43], s6 offen sc1
    buffer_load_dword v25, v13, s[40:43], s7 offen sc1
    s_mov_b64 exec, 0xffffff
    buffer_store_dwordx2 v[68:69], v81, s[40:43], 0 offen sc1
    s_mov_b64 exec, -1
    s_mov_b64 exec, 0xffffff
    buffer_store_dwordx2 v[82:83], v92, s[40:43], 0 offen sc1
    s_mov_b64 exec, -1
    s_lshl_b32 s6, s58, 6
    s_lshl_b32 s5, s66, 4
    s_add_u32 s6, s6, s5
    s_lshl_b32 s6, s6, 13
    s_lshl_b32 s5, s59, 8
    s_add_u32 s7, s6, s5
    s_lshl_b32 s6, s66, 12
    s_add_u32 m0, s6, 114688
    s_add_u32 s5, s7, 0
    buffer_load_dwordx4 v7, s[16:19], s5 offen nt lds
    s_add_u32 m0, s6, 115712
    s_add_u32 s5, s7, 32768
    buffer_load_dwordx4 v8, s[16:19], s5 offen nt lds
    s_add_u32 m0, s6, 116736
    s_add_u32 s5, s7, 65536
    buffer_load_dwordx4 v7, s[16:19], s5 offen nt lds
    s_add_u32 m0, s6, 117760
    s_add_u32 s5, s7, 98304
    buffer_load_dwordx4 v8, s[16:19], s5 offen nt lds
    s_mov_b64 exec, 1
    ds_add_u32 v10, v11 offset:8
    s_mov_b64 exec, -1
    s_waitcnt vmcnt(6)
    s_branch Lg1c_3
Lg1_2:
    s_cmp_lt_u32 s98, 12
    s_cselect_b32 s4, 8388608, 0
    s_add_u32 s5, s90, 0
    s_lshl_b32 s6, s59, 13
    s_lshl_b32 s7, s5, 7
    s_add_u32 s6, s6, s7
    s_add_u32 s6, s6, s4
    s_add_u32 s6, s6, 65536
    s_lshl_b32 s7, s59, 12
    s_lshl_b32 s5, s5, 6
    s_add_u32 s7, s7, s5
    s_add_u32 s7, s7, s4
    s_add_u32 s7, s7, 393216
    buffer_load_dwordx4 v[16:19], v12, s[40:43], s6 offen sc1
    buffer_load_dword v24, v13, s[40:43], s7 offen sc1
    s_cmp_lt_u32 s98, 12
    s_cselect_b32 s4, 8388608, 0
    s_add_u32 s5, s90, 1
    s_lshl_b32 s6, s59, 13
    s_lshl_b32 s7, s5, 7
    s_add_u32 s6, s6, s7
    s_add_u32 s6, s6, s4
    s_add_u32 s6, s6, 65536
    s_lshl_b32 s7, s59, 12
    s_lshl_b32 s5, s5, 6
    s_add_u32 s7, s7, s5
    s_add_u32 s7, s7, s4
    s_add_u32 s7, s7, 393216
    buffer_load_dwordx4 v[20:23], v12, s[40:43], s6 offen sc1
    buffer_load_dword v25, v13, s[40:43], s7 offen sc1
    s_waitcnt vmcnt(0)
Lg1c_3:
    v_add3_u32 v196, v16, v17, v18
    v_add_u32 v196, v196, v19
    v_add3_u32 v197, v20, v21, v22
    v_add_u32 v197, v197, v23
    v_add_u32_dpp v196, v196, v196 quad_perm:[1,0,3,2] row_mask:0xf bank_mask:0xf
    s_nop 0
    v_add_u32_dpp v197, v197, v197 quad_perm:[1,0,3,2] row_mask:0xf bank_mask:0xf
    v_add_u32_dpp v196, v196, v196 quad_perm:[2,3,0,1] row_mask:0xf bank_mask:0xf
    s_nop 0
    v_add_u32_dpp v197, v197, v197 quad_perm:[2,3,0,1] row_mask:0xf bank_mask:0xf
    v_add_u32_dpp v196, v196, v196 row_half_mirror row_mask:0xf bank_mask:0xf
    s_nop 0
    v_add_u32_dpp v197, v197, v197 row_half_mirror row_mask:0xf bank_mask:0xf
    v_add_u32 v196, v196, v4
    v_add_u32 v197, v197, v4
    v_xor_b32 v196, v196, v24
    v_xor_b32 v197, v197, v25
    v_or_b32 v196, v196, v197
    v_cmp_ne_u32 vcc, 0, v196
    s_cbranch_vccz Lok_4
    s_add_u32 s98, s98, 1
    s_sleep 1
    s_cmp_lt_u32 s98, 200000
    s_cbranch_scc1 Lg1_2
    s_or_b32 s99, s99, 1
Lok_4:
    v_add_f32_dpp v16, v16, v16 row_ror:8 row_mask:0xf bank_mask:0xf
    v_add_f32_dpp v17, v17, v17 row_ror:8 row_mask:0xf bank_mask:0xf
    v_add_f32_dpp v18, v18, v18 row_ror:8 row_mask:0xf bank_mask:0xf
    v_add_f32_dpp v19, v19, v19 row_ror:8 row_mask:0xf bank_mask:0xf
    v_add_f32_dpp v20, v20, v20 row_ror:8 row_mask:0xf bank_mask:0xf
    v_add_f32_dpp v21, v21, v21 row_ror:8 row_mask:0xf bank_mask:0xf
    v_add_f32_dpp v22, v22, v22 row_ror:8 row_mask:0xf bank_mask:0xf
    v_add_f32_dpp v23, v23, v23 row_ror:8 row_mask:0xf bank_mask:0xf
    v_mov_b32 v200, v16
    v_mov_b32 v201, v17
    v_mov_b32 v202, v18
    v_mov_b32 v203, v19
    v_mov_b32 v204, v20
    v_mov_b32 v205, v21
    v_mov_b32 v206, v22
    v_mov_b32 v207, v23
    v_permlane16_swap_b32 v16, v200
    v_permlane16_swap_b32 v17, v201
    v_permlane16_swap_b32 v18, v202
    v_permlane16_swap_b32 v19, v203
    v_permlane16_swap_b32 v20, v204
    v_permlane16_swap_b32 v21, v205
    v_permlane16_swap_b32 v22, v206
    v_permlane16_swap_b32 v23, v207
    v_add_f32 v16, v16, v200
    v_add_f32 v17, v17, v201
    v_add_f32 v18, v18, v202
    v_add_f32 v19, v19, v203
    v_add_f32 v20, v20, v204
    v_add_f32 v21, v21, v205
    v_add_f32 v22, v22, v206
    v_add_f32 v23, v23, v207
    v_mov_b32 v200, v16
    v_mov_b32 v201, v17
    v_mov_b32 v202, v18
    v_mov_b32 v203, v19
    v_mov_b32 v204, v20
    v_mov_b32 v205, v21
    v_mov_b32 v206, v22
    v_mov_b32 v207, v23
    v_permlane32_swap_b32 v16, v200
    v_permlane32_swap_b32 v17, v201
    v_permlane32_swap_b32 v18, v202
    v_permlane32_swap_b32 v19, v203
    v_permlane32_swap_b32 v20, v204
    v_permlane32_swap_b32 v21, v205
    v_permlane32_swap_b32 v22, v206
    v_permlane32_swap_b32 v23, v207
    v_add_f32 v16, v16, v200
    v_add_f32 v17, v17, v201
    v_add_f32 v18, v18, v202
    v_add_f32 v19, v19, v203
    v_add_f32 v20, v20, v204
    v_add_f32 v21, v21, v205
    v_add_f32 v22, v22, v206
    v_add_f32 v23, v23, v207
    v_cvt_pk_bf16_f32 v200, v16, v18
    v_cvt_pk_bf16_f32 v201, v17, v19
    v_cvt_pk_bf16_f32 v202, v20, v22
    v_cvt_pk_bf16_f32 v203, v21, v23
    s_lshl_b32 s69, s66, 6
    s_add_u32 s69, s69, 147968
    v_lshl_add_u32 v196, v1, 2, s69
    s_mov_b64 exec, 0xff
    ds_write_b32 v196, v200 offset:0
    ds_write_b32 v196, v201 offset:256
    ds_write_b32 v196, v202 offset:32
    ds_write_b32 v196, v203 offset:288
    s_mov_b64 exec, -1
    s_waitcnt vmcnt(0)
    s_mov_b64 exec, 1
    ds_add_u32 v10, v11 offset:12
    s_mov_b64 exec, -1
Lw_5:
    ds_read_b32 v197, v10 offset:12
    s_waitcnt lgkmcnt(0)
    v_readfirstlane_b32 s71, v197
    s_nop 0
    s_cmp_lt_u32 s71, 4
    s_cbranch_scc1 Lw_5
    ds_read_b128 v[32:35], v78 offset:0
    ds_read_b128 v[48:51], v88
    ds_read_b128 v[36:39], v78 offset:64
    ds_read_b128 v[52:55], v89
    ds_read_b128 v[40:43], v78 offset:128
    ds_read_b128 v[56:59], v90
    ds_read_b128 v[44:47], v78 offset:192
    ds_read_b128 v[60:63], v91
    s_waitcnt lgkmcnt(6)
    v_mfma_f32_16x16x32_bf16 v[64:67], v[32:35], v[48:51], 0
    s_waitcnt lgkmcnt(4)
    v_mfma_f32_16x16x32_bf16 v[64:67], v[36:39], v[52:55], v[64:67]
    s_waitcnt lgkmcnt(2)
    v_mfma_f32_16x16x32_bf16 v[64:67], v[40:43], v[56:59], v[64:67]
    s_waitcnt lgkmcnt(0)
    v_mfma_f32_16x16x32_bf16 v[64:67], v[44:47], v[60:63], v[64:67]
    s_lshl_b32 s69, s66, 5
    s_add_u32 s69, s69, 149632
    v_lshl_add_u32 v196, v2, 1, s69
    s_nop 4
    v_cvt_pk_bf16_f32 v64, v64, v65
    s_mov_b64 exec, 0xffff
    ds_write_b16 v196, v64
    ds_write_b16_d16_hi v196, v64 offset:128
    s_mov_b64 exec, -1
    s_mov_b64 exec, 1
    ds_add_u32 v10, v11 offset:20
    s_mov_b64 exec, -1
    s_cmp_lg_u32 s66, 0
    s_cbranch_scc1 Lnq_6
    v_add_u32 v197, 149632, v6
    v_lshrrev_b32 v198, 3, v1
    v_and_b32 v199, 7, v1
    v_lshlrev_b32 v200, 15, v198
    v_lshl_add_u32 v200, v199, 4, v200
    v_lshlrev_b32 v201, 14, v198
    v_lshl_add_u32 v201, v199, 3, v201
    s_lshl_b32 s69, s59, 10
    s_lshl_b32 s70, s58, 7
    s_add_u32 s69, s69, s70
    s_add_u32 s69, s69, 1048576
    s_lshl_b32 s70, s72, 6
    s_add_u32 s70, s70, 1179648
Lw_7:
    ds_read_b32 v196, v10 offset:28
    s_waitcnt lgkmcnt(0)
    v_readfirstlane_b32 s71, v196
    s_nop 0
    s_cmp_lt_u32 s71, 1
    s_cbranch_scc1 Lw_7
Lw_8:
    ds_read_b32 v196, v10 offset:20
    s_waitcnt lgkmcnt(0)
    v_readfirstlane_b32 s71, v196
    s_nop 0
    s_cmp_lt_u32 s71, 4
    s_cbranch_scc1 Lw_8
    ds_read_b128 v[84:87], v197
    s_waitcnt lgkmcnt(0)
    s_mov_b64 exec, 0xffff
    buffer_store_dwordx4 v[84:87], v200, s[40:43], s69 offen sc1
    s_mov_b64 exec, -1
    v_add3_u32 v88, v84, v85, v86
    v_add_u32 v88, v88, v87
    s_nop 1
    v_add_u32_dpp v88, v88, v88 quad_perm:[1,0,3,2] row_mask:0xf bank_mask:0xf
    s_nop 1
    v_add_u32_dpp v88, v88, v88 quad_perm:[2,3,0,1] row_mask:0xf bank_mask:0xf
    s_nop 1
    v_add_u32_dpp v88, v88, v88 row_half_mirror row_mask:0xf bank_mask:0xf
    v_add_u32 v88, v88, v4
    s_mov_b64 exec, 0xffff
    buffer_store_dwordx2 v[88:89], v201, s[40:43], s70 offen sc1
    s_mov_b64 exec, -1
Lnq_6:
    v_and_b32 v196, 7, v1
    v_lshlrev_b32 v196, 1, v196
    v_lshlrev_b32 v197, 10, v2
    s_lshl_b32 s69, s66, 14
    v_add_u32 v198, 0, v3
    v_xor_b32 v198, v198, v196
    v_lshl_add_u32 v198, v198, 4, v197
    v_add_u32 v16, s69, v198
    v_add_u32 v20, 65536, v16
    v_add_u32 v24, 131072, v198
    v_add_u32 v198, 4, v3
    v_xor_b32 v198, v198, v196
    v_lshl_add_u32 v198, v198, 4, v197
    v_add_u32 v17, s69, v198
    v_add_u32 v21, 65536, v17
    v_add_u32 v25, 131072, v198
    v_add_u32 v198, 8, v3
    v_xor_b32 v198, v198, v196
    v_lshl_add_u32 v198, v198, 4, v197
    v_add_u32 v18, s69, v198
    v_add_u32 v22, 65536, v18
    v_add_u32 v26, 131072, v198
    v_add_u32 v198, 12, v3
    v_xor_b32 v198, v198, v196
    v_lshl_add_u32 v198, v198, 4, v197
    v_add_u32 v19, s69, v198
    v_add_u32 v23, 65536, v19
    v_add_u32 v27, 131072, v198
    s_lshl_b32 s69, s66, 2
    s_add_u32 s69, s69, 148512
    v_mov_b32 v199, s69
Ltw_9:
    ds_read_b32 v200, v199
    s_waitcnt lgkmcnt(0)
    v_readfirstlane_b32 s71, v200
    s_nop 0
    s_cmp_ge_u32 s71, 4
    s_cbranch_scc1 Ltwd_10
    s_sleep 2
    s_branch Ltw_9
Ltwd_10:
    ds_read_b128 v[36:39], v16 offset:0
    ds_read_b128 v[40:43], v17 offset:0
    ds_read_b128 v[44:47], v18 offset:0
    ds_read_b128 v[48:51], v19 offset:0
    ds_read_b128 v[52:55], v16 offset:256
    ds_read_b128 v[56:59], v17 offset:256
    ds_read_b128 v[60:63], v18 offset:256
    ds_read_b128 v[64:67], v19 offset:256
    ds_read_b128 v[68:71], v16 offset:512
    ds_read_b128 v[72:75], v17 offset:512
    ds_read_b128 v[76:79], v18 offset:512
    ds_read_b128 v[80:83], v19 offset:512
    ds_read_b128 v[84:87], v16 offset:768
    ds_read_b128 v[88:91], v17 offset:768
    ds_read_b128 v[92:95], v18 offset:768
    ds_read_b128 v[96:99], v19 offset:768
    s_cmp_ge_u32 s66, 3
    s_cbranch_scc1 Lt7_11
    s_lshl_b32 s69, s66, 2
    s_add_u32 s69, s69, 148528
    v_mov_b32 v199, s69
Ltw_12:
    ds_read_b32 v200, v199
    s_waitcnt lgkmcnt(0)
    v_readfirstlane_b32 s71, v200
    s_nop 0
    s_cmp_ge_u32 s71, 4
    s_cbranch_scc1 Ltwd_13
    s_sleep 2
    s_branch Ltw_12
Ltwd_13:
    ds_read_b128 v[100:103], v20 offset:0
    ds_read_b128 v[104:107], v21 offset:0
    ds_read_b128 v[108:111], v22 offset:0
    ds_read_b128 v[112:115], v23 offset:0
    ds_read_b128 v[116:119], v20 offset:256
    ds_read_b128 v[120:123], v21 offset:256
    ds_read_b128 v[124:127], v22 offset:256
    ds_read_b128 v[128:131], v23 offset:256
    ds_read_b128 v[132:135], v20 offset:512
    ds_read_b128 v[136:139], v21 offset:512
    ds_read_b128 v[140:143], v22 offset:512
    ds_read_b128 v[144:147], v23 offset:512
    ds_read_b128 v[148:151], v20 offset:768
    ds_read_b128 v[152:155], v21 offset:768
    ds_read_b128 v[156:159], v22 offset:768
    ds_read_b128 v[160:163], v23 offset:768
Lt7_11:
    s_branch L_join
L_shead:
    s_cmp_lg_u32 s66, 0
    s_cbranch_scc1 Lni_15
    s_cmp_lg_u32 s58, 0
    s_cbranch_scc1 Lni_14
    v_mov_b32 v196, 0
    v_mov_b32 v197, 0
    v_mov_b32 v198, 0
    v_mov_b32 v199, 0
    s_lshl_b32 s70, s59, 9
    s_add_u32 s70, s70, 3670016
    s_lshl_b32 s4, s56, 9
    s_add_u32 s4, s4, 3702784
    s_cmp_eq_u32 s57, 3
    s_cselect_b32 s4, s4, 3710976
    v_mov_b32 v200, s70
    v_mov_b32 v202, s4
    v_cmp_lt_u32 vcc, 15, v1
    s_nop 1
    v_cndmask_b32 v200, v200, v202, vcc
    v_bfe_u32 v201, v1, 2, 2
    v_lshl_add_u32 v200, v201, 7, v200
    v_and_b32 v201, 3, v1
    v_lshl_add_u32 v200, v201, 4, v200
    s_mov_b32 exec_lo, 0xffffffff
    s_mov_b32 exec_hi, 0x0
    buffer_store_dwordx4 v[196:199], v200, s[40:43], 0 offen sc1
    s_mov_b64 exec, -1
    s_waitcnt vmcnt(0)
Lni_14:
    s_mov_b64 exec, 1
    ds_add_u32 v10, v11 offset:28
    s_mov_b64 exec, -1
Lni_15:
    v_lshrrev_b32 v204, 2, v2
    v_lshl_add_u32 v204, v3, 2, v204
    v_and_b32 v205, 7, v204
    v_lshlrev_b32 v205, 1, v205
    v_lshlrev_b32 v204, 10, v204
    v_and_b32 v206, 1, v2
    v_lshl_add_u32 v204, v206, 3, v204
    v_bfe_u32 v206, v2, 1, 1
    s_lshl_b32 s69, s3, 3
    v_add_u32 v206, s69, v206
    v_add_u32 v207, 0, v206
    v_xor_b32 v207, v207, v205
    v_lshl_add_u32 v208, v207, 4, v204
    v_add_u32 v212, 65536, v208
    v_add_u32 v207, 2, v206
    v_xor_b32 v207, v207, v205
    v_lshl_add_u32 v209, v207, 4, v204
    v_add_u32 v213, 65536, v209
    v_add_u32 v207, 4, v206
    v_xor_b32 v207, v207, v205
    v_lshl_add_u32 v210, v207, 4, v204
    v_add_u32 v214, 65536, v210
    v_add_u32 v207, 6, v206
    v_xor_b32 v207, v207, v205
    v_lshl_add_u32 v211, v207, 4, v204
    v_add_u32 v215, 65536, v211
    v_lshrrev_b32 v204, 3, v1
    v_bfe_u32 v205, v1, 4, 2
    v_lshlrev_b32 v205, 1, v205
    v_and_b32 v206, 7, v1
    v_xor_b32 v206, v206, v205
    v_lshlrev_b32 v206, 4, v206
    v_lshl_add_u32 v216, v204, 10, v206
    v_lshl_add_u32 v220, v204, 7, v206
    v_mul_u32_u24 v219, 2752, v204
    v_add_u32 v219, v219, v206
    v_lshlrev_b32 v205, 1, v3
    v_xor_b32 v206, v2, v205
    v_lshlrev_b32 v206, 4, v206
    v_lshl_add_u32 v217, v3, 13, v206
    v_xor_b32 v218, 128, v217
    s_lshl_b32 s68, s58, 6
    s_lshl_b32 s69, s66, 4
    s_add_u32 s68, s68, s69
    s_lshl_b32 s69, s68, 13
    s_lshl_b32 s70, s59, 8
    s_add_u32 s80, s69, s70
    s_lshl_b32 s70, s58, 7
    s_lshl_b32 s82, s59, 7
    s_lshl_b32 s71, s3, 4
    s_add_u32 s82, s82, s71
    s_lshl_b32 s82, s82, 10
    s_add_u32 s82, s82, s70
    s_lshl_b32 s68, s58, 6
    s_lshl_b32 s69, s66, 4
    s_add_u32 s68, s68, s69
    s_mul_i32 s81, s68, 2752
    s_lshl_b32 s69, s64, 7
    s_add_u32 s81, s81, s69
    s_lshl_b32 s83, s64, 6
    s_lshl_b32 s71, s3, 3
    s_add_u32 s83, s83, s71
    s_lshl_b32 s83, s83, 10
    s_add_u32 s83, s83, s70
    s_lshl_b32 s68, s66, 1
    v_xor_b32 v7, s68, v1
    v_lshlrev_b32 v7, 4, v7
    s_add_u32 s68, s68, 8
    v_xor_b32 v8, s68, v1
    v_lshlrev_b32 v8, 4, v8
    s_lshl_b32 s68, s61, 23
    s_lshl_b32 s5, s62, 17
    s_add_u32 s68, s68, s5
    s_lshl_b32 s5, s66, 10
    s_add_u32 s68, s68, s5
    s_mov_b32 m0, s5
    s_lshl_b32 s69, s61, 5
    s_lshl_b32 s70, s60, 4
    s_add_u32 s69, s69, s70
    s_lshl_b32 s70, s66, 2
    s_add_u32 s69, s69, s70
    s_lshl_b32 s74, s69, 10
    s_add_u32 s74, s74, 1048576
    s_lshl_b32 s75, s69, 9
    s_add_u32 s75, s75, 1179648
    v_lshrrev_b32 v9, 3, v1
    v_lshlrev_b32 v9, 6, v9
    s_lshl_b32 s71, s66, 2
    s_add_u32 s71, s71, 0
    s_and_b32 s4, s71, 7
    s_lshl_b32 s4, s4, 1
    s_lshl_b32 s5, s71, 10
    s_add_u32 s5, s5, 131072
    v_xor_b32 v36, s4, v1
    v_lshlrev_b32 v36, 4, v36
    v_add_u32 v36, s5, v36
    s_lshl_b32 s71, s66, 2
    s_add_u32 s71, s71, 1
    s_and_b32 s4, s71, 7
    s_lshl_b32 s4, s4, 1
    s_lshl_b32 s5, s71, 10
    s_add_u32 s5, s5, 131072
    v_xor_b32 v37, s4, v1
    v_lshlrev_b32 v37, 4, v37
    v_add_u32 v37, s5, v37
    s_lshl_b32 s71, s66, 2
    s_add_u32 s71, s71, 2
    s_and_b32 s4, s71, 7
    s_lshl_b32 s4, s4, 1
    s_lshl_b32 s5, s71, 10
    s_add_u32 s5, s5, 131072
    v_xor_b32 v38, s4, v1
    v_lshlrev_b32 v38, 4, v38
    v_add_u32 v38, s5, v38
    s_lshl_b32 s71, s66, 2
    s_add_u32 s71, s71, 3
    s_and_b32 s4, s71, 7
    s_lshl_b32 s4, s4, 1
    s_lshl_b32 s5, s71, 10
    s_add_u32 s5, s5, 131072
    v_xor_b32 v39, s4, v1
    v_lshlrev_b32 v39, 4, v39
    v_add_u32 v39, s5, v39
    buffer_load_dwordx4 v7, s[8:11], s68 offen nt lds
    s_add_u32 m0, m0, 4096
    s_add_u32 s68, s68, 4096
    buffer_load_dwordx4 v8, s[8:11], s68 offen nt lds
    s_add_u32 m0, m0, 4096
    s_add_u32 s68, s68, 4096
Lw_16:
    ds_read_b32 v204, v10 offset:16
    s_waitcnt lgkmcnt(0)
    v_readfirstlane_b32 s71, v204
    s_nop 0
    s_cmp_ge_u32 s71, 4
    s_cbranch_scc1 Lwd_17
    s_sleep 1
    s_branch Lw_16
Lwd_17:
Lw_18:
    ds_read_b32 v204, v10 offset:8
    s_waitcnt lgkmcnt(0)
    v_readfirstlane_b32 s71, v204
    s_nop 0
    s_cmp_ge_u32 s71, 4
    s_cbranch_scc1 Lwd_19
    s_sleep 1
    s_branch Lw_18
Lwd_19:
    buffer_load_dwordx4 v7, s[8:11], s68 offen nt lds
    s_add_u32 m0, m0, 4096
    s_add_u32 s68, s68, 4096
    buffer_load_dwordx4 v8, s[8:11], s68 offen nt lds
    s_add_u32 m0, m0, 4096
    s_add_u32 s68, s68, 4096
    buffer_load_dwordx4 v7, s[8:11], s68 offen nt lds
    s_add_u32 m0, m0, 4096
    s_add_u32 s68, s68, 4096
    buffer_load_dwordx4 v8, s[8:11], s68 offen nt lds
    s_add_u32 m0, m0, 4096
    s_add_u32 s68, s68, 4096
    buffer_load_dwordx4 v7, s[8:11], s68 offen nt lds
    s_add_u32 m0, m0, 4096
    s_add_u32 s68, s68, 4096
    buffer_load_dwordx4 v8, s[8:11], s68 offen nt lds
    s_add_u32 m0, m0, 4096
    s_add_u32 s68, s68, 4096
    buffer_load_dwordx4 v7, s[8:11], s68 offen nt lds
    s_add_u32 m0, m0, 4096
    s_add_u32 s68, s68, 4096
    buffer_load_dwordx4 v8, s[8:11], s68 offen nt lds
    s_add_u32 m0, m0, 4096
    s_add_u32 s68, s68, 4096
    buffer_load_dwordx4 v7, s[8:11], s68 offen nt lds
    s_add_u32 m0, m0, 4096
    s_add_u32 s68, s68, 4096
    buffer_load_dwordx4 v8, s[8:11], s68 offen nt lds
    s_add_u32 m0, m0, 4096
    s_add_u32 s68, s68, 4096
    buffer_load_dwordx4 v7, s[8:11], s68 offen nt lds
    s_add_u32 m0, m0, 4096
    s_add_u32 s68, s68, 4096
    buffer_load_dwordx4 v8, s[8:11], s68 offen nt lds
    s_add_u32 m0, m0, 4096
    s_add_u32 s68, s68, 4096
    buffer_load_dwordx4 v7, s[8:11], s68 offen nt lds
    s_add_u32 m0, m0, 4096
    s_add_u32 s68, s68, 4096
    buffer_load_dwordx4 v8, s[8:11], s68 offen nt lds
    s_add_u32 m0, m0, 4096
    s_add_u32 s68, s68, 4096
    s_waitcnt vmcnt(12)
    s_mov_b64 exec, 1
    ds_add_u32 v10, v11 offset:32
    s_mov_b64 exec, -1
    buffer_load_dwordx4 v7, s[8:11], s68 offen nt lds
    s_add_u32 m0, m0, 4096
    s_add_u32 s68, s68, 4096
    buffer_load_dwordx4 v8, s[8:11], s68 offen nt lds
    s_add_u32 m0, m0, 4096
    s_add_u32 s68, s68, 4096
    buffer_load_dwordx4 v7, s[8:11], s68 offen nt lds
    s_add_u32 m0, m0, 4096
    s_add_u32 s68, s68, 4096
    buffer_load_dwordx4 v8, s[8:11], s68 offen nt lds
    s_add_u32 m0, m0, 4096
    s_add_u32 s68, s68, 4096
    s_waitcnt vmcnt(12)
    s_mov_b64 exec, 1
    ds_add_u32 v10, v11 offset:36
    s_mov_b64 exec, -1
    buffer_load_dwordx4 v7, s[8:11], s68 offen nt lds
    s_add_u32 m0, m0, 4096
    s_add_u32 s68, s68, 4096
    buffer_load_dwordx4 v8, s[8:11], s68 offen nt lds
    s_add_u32 m0, m0, 4096
    s_add_u32 s68, s68, 4096
    buffer_load_dwordx4 v7, s[8:11], s68 offen nt lds
    s_add_u32 m0, m0, 4096
    s_add_u32 s68, s68, 4096
    buffer_load_dwordx4 v8, s[8:11], s68 offen nt lds
    s_add_u32 m0, m0, 4096
    s_add_u32 s68, s68, 4096
    s_waitcnt vmcnt(12)
    s_mov_b64 exec, 1
    ds_add_u32 v10, v11 offset:40
    s_mov_b64 exec, -1
    buffer_load_dwordx4 v7, s[8:11], s68 offen nt lds
    s_add_u32 m0, m0, 4096
    s_add_u32 s68, s68, 4096
    buffer_load_dwordx4 v8, s[8:11], s68 offen nt lds
    s_add_u32 m0, m0, 4096
    s_add_u32 s68, s68, 4096
    buffer_load_dwordx4 v7, s[8:11], s68 offen nt lds
    s_add_u32 m0, m0, 4096
    s_add_u32 s68, s68, 4096
    buffer_load_dwordx4 v8, s[8:11], s68 offen nt lds
    s_add_u32 m0, m0, 4096
    s_add_u32 s68, s68, 4096
    s_waitcnt vmcnt(12)
    s_mov_b64 exec, 1
    ds_add_u32 v10, v11 offset:44
    s_mov_b64 exec, -1
Lw_20:
    ds_read_b32 v204, v10 offset:20
    s_waitcnt lgkmcnt(0)
    v_readfirstlane_b32 s71, v204
    s_nop 0
    s_cmp_ge_u32 s71, 4
    s_cbranch_scc1 Lwd_21
    s_sleep 1
    s_branch Lw_20
Lwd_21:
    buffer_load_dwordx4 v7, s[8:11], s68 offen nt lds
    s_add_u32 m0, m0, 4096
    s_add_u32 s68, s68, 4096
    buffer_load_dwordx4 v8, s[8:11], s68 offen nt lds
    s_add_u32 m0, m0, 4096
    s_add_u32 s68, s68, 4096
    buffer_load_dwordx4 v7, s[8:11], s68 offen nt lds
    s_add_u32 m0, m0, 4096
    s_add_u32 s68, s68, 4096
    buffer_load_dwordx4 v8, s[8:11], s68 offen nt lds
    s_add_u32 m0, m0, 4096
    s_add_u32 s68, s68, 4096
    s_waitcnt vmcnt(12)
    s_mov_b64 exec, 1
    ds_add_u32 v10, v11 offset:48
    s_mov_b64 exec, -1
    s_waitcnt vmcnt(4)
    s_mov_b64 exec, 1
    ds_add_u32 v10, v11 offset:52
    s_mov_b64 exec, -1
    s_mov_b64 exec, 1
    ds_add_u32 v10, v11 offset:56
    s_mov_b64 exec, -1
    s_mov_b32 s98, 0
Lg2_22:
    buffer_load_dwordx4 v[16:19], v6, s[40:43], s74 offen offset:0 sc1
    buffer_load_dwordx4 v[20:23], v6, s[40:43], s74 offen offset:1024 sc1
    buffer_load_dwordx4 v[24:27], v6, s[40:43], s74 offen offset:2048 sc1
    buffer_load_dwordx4 v[28:31], v6, s[40:43], s74 offen offset:3072 sc1
    buffer_load_dword v32, v9, s[40:43], s75 offen offset:0 sc1
    buffer_load_dword v33, v9, s[40:43], s75 offen offset:512 sc1
    buffer_load_dword v34, v9, s[40:43], s75 offen offset:1024 sc1
    buffer_load_dword v35, v9, s[40:43], s75 offen offset:1536 sc1
    s_waitcnt vmcnt(0)
    v_add3_u32 v196, v16, v17, v18
    v_add_u32 v196, v196, v19
    v_add3_u32 v197, v20, v21, v22
    v_add_u32 v197, v197, v23
    v_add3_u32 v198, v24, v25, v26
    v_add_u32 v198, v198, v27
    v_add3_u32 v199, v28, v29, v30
    v_add_u32 v199, v199, v31
    v_add_u32_dpp v196, v196, v196 quad_perm:[1,0,3,2] row_mask:0xf bank_mask:0xf
    v_add_u32_dpp v197, v197, v197 quad_perm:[1,0,3,2] row_mask:0xf bank_mask:0xf
    v_add_u32_dpp v198, v198, v198 quad_perm:[1,0,3,2] row_mask:0xf bank_mask:0xf
    v_add_u32_dpp v199, v199, v199 quad_perm:[1,0,3,2] row_mask:0xf bank_mask:0xf
    v_add_u32_dpp v196, v196, v196 quad_perm:[2,3,0,1] row_mask:0xf bank_mask:0xf
    v_add_u32_dpp v197, v197, v197 quad_perm:[2,3,0,1] row_mask:0xf bank_mask:0xf
    v_add_u32_dpp v198, v198, v198 quad_perm:[2,3,0,1] row_mask:0xf bank_mask:0xf
    v_add_u32_dpp v199, v199, v199 quad_perm:[2,3,0,1] row_mask:0xf bank_mask:0xf
    v_add_u32_dpp v196, v196, v196 row_half_mirror row_mask:0xf bank_mask:0xf
    v_add_u32_dpp v197, v197, v197 row_half_mirror row_mask:0xf bank_mask:0xf
    v_add_u32_dpp v198, v198, v198 row_half_mirror row_mask:0xf bank_mask:0xf
    v_add_u32_dpp v199, v199, v199 row_half_mirror row_mask:0xf bank_mask:0xf
    v_add_u32 v196, v196, v4
    v_add_u32 v197, v197, v4
    v_add_u32 v198, v198, v4
    v_add_u32 v199, v199, v4
    v_xor_b32 v196, v196, v32
    v_xor_b32 v197, v197, v33
    v_xor_b32 v198, v198, v34
    v_xor_b32 v199, v199, v35
    v_or3_b32 v196, v196, v197, v198
    v_or_b32 v196, v196, v199
    v_cmp_ne_u32 vcc, 0, v196
    s_cbranch_vccz Lok_23
    s_add_u32 s98, s98, 1
    s_sleep 6
    s_cmp_lt_u32 s98, 200000
    s_cbranch_scc1 Lg2_22
    s_or_b32 s99, s99, 2
Lok_23:
    ds_write_b128 v36, v[16:19]
    ds_write_b128 v37, v[20:23]
    ds_write_b128 v38, v[24:27]
    ds_write_b128 v39, v[28:31]
L_join:
    s_nop 4
    s_waitcnt vmcnt(0) lgkmcnt(0)
    s_barrier
    s_cmp_ge_u32 s3, 4
    s_cbranch_scc1 L_sw_att
    s_cmp_ge_u32 s66, 3
    s_cbranch_scc1 Llate_24
    ds_read_b128 v[164:167], v24 offset:0
    ds_read_b128 v[168:171], v25 offset:0
    ds_read_b128 v[172:175], v26 offset:0
    ds_read_b128 v[176:179], v27 offset:0
    ds_read_b128 v[180:183], v24 offset:256
    ds_read_b128 v[184:187], v25 offset:256
    ds_read_b128 v[188:191], v26 offset:256
    ds_read_b128 v[192:195], v27 offset:256
    s_waitcnt lgkmcnt(4)
    v_mfma_f32_16x16x32_bf16 v[28:31], v[36:39], v[164:167], 0
    v_mfma_f32_16x16x32_bf16 v[32:35], v[100:103], v[164:167], 0
    v_mfma_f32_16x16x32_bf16 v[28:31], v[40:43], v[168:171], v[28:31]
    v_mfma_f32_16x16x32_bf16 v[32:35], v[104:107], v[168:171], v[32:35]
    v_mfma_f32_16x16x32_bf16 v[28:31], v[44:47], v[172:175], v[28:31]
    v_mfma_f32_16x16x32_bf16 v[32:35], v[108:111], v[172:175], v[32:35]
    v_mfma_f32_16x16x32_bf16 v[28:31], v[48:51], v[176:179], v[28:31]
    v_mfma_f32_16x16x32_bf16 v[32:35], v[112:115], v[176:179], v[32:35]
    ds_read_b128 v[164:167], v24 offset:512
    ds_read_b128 v[168:171], v25 offset:512
    ds_read_b128 v[172:175], v26 offset:512
    ds_read_b128 v[176:179], v27 offset:512
    s_waitcnt lgkmcnt(4)
    v_mfma_f32_16x16x32_bf16 v[28:31], v[52:55], v[180:183], v[28:31]
    v_mfma_f32_16x16x32_bf16 v[32:35], v[116:119], v[180:183], v[32:35]
    v_mfma_f32_16x16x32_bf16 v[28:31], v[56:59], v[184:187], v[28:31]
    v_mfma_f32_16x16x32_bf16 v[32:35], v[120:123], v[184:187], v[32:35]
    v_mfma_f32_16x16x32_bf16 v[28:31], v[60:63], v[188:191], v[28:31]
    v_mfma_f32_16x16x32_bf16 v[32:35], v[124:127], v[188:191], v[32:35]
    v_mfma_f32_16x16x32_bf16 v[28:31], v[64:67], v[192:195], v[28:31]
    v_mfma_f32_16x16x32_bf16 v[32:35], v[128:131], v[192:195], v[32:35]
    ds_read_b128 v[180:183], v24 offset:768
    ds_read_b128 v[184:187], v25 offset:768
    ds_read_b128 v[188:191], v26 offset:768
    ds_read_b128 v[192:195], v27 offset:768
    s_waitcnt lgkmcnt(4)
    v_mfma_f32_16x16x32_bf16 v[28:31], v[68:71], v[164:167], v[28:31]
    v_mfma_f32_16x16x32_bf16 v[32:35], v[132:135], v[164:167], v[32:35]
    v_mfma_f32_16x16x32_bf16 v[28:31], v[72:75], v[168:171], v[28:31]
    v_mfma_f32_16x16x32_bf16 v[32:35], v[136:139], v[168:171], v[32:35]
    v_mfma_f32_16x16x32_bf16 v[28:31], v[76:79], v[172:175], v[28:31]
    v_mfma_f32_16x16x32_bf16 v[32:35], v[140:143], v[172:175], v[32:35]
    v_mfma_f32_16x16x32_bf16 v[28:31], v[80:83], v[176:179], v[28:31]
    v_mfma_f32_16x16x32_bf16 v[32:35], v[144:147], v[176:179], v[32:35]
    s_waitcnt lgkmcnt(0)
    v_mfma_f32_16x16x32_bf16 v[28:31], v[84:87], v[180:183], v[28:31]
    v_mfma_f32_16x16x32_bf16 v[32:35], v[148:151], v[180:183], v[32:35]
    v_mfma_f32_16x16x32_bf16 v[28:31], v[88:91], v[184:187], v[28:31]
    v_mfma_f32_16x16x32_bf16 v[32:35], v[152:155], v[184:187], v[32:35]
    v_mfma_f32_16x16x32_bf16 v[28:31], v[92:95], v[188:191], v[28:31]
    v_mfma_f32_16x16x32_bf16 v[32:35], v[156:159], v[188:191], v[32:35]
    v_mfma_f32_16x16x32_bf16 v[28:31], v[96:99], v[192:195], v[28:31]
    v_mfma_f32_16x16x32_bf16 v[32:35], v[160:163], v[192:195], v[32:35]
    s_branch Lsd_25
Llate_24:
    ds_read_b128 v[164:167], v24 offset:0
    ds_read_b128 v[100:103], v20 offset:0
    ds_read_b128 v[168:171], v25 offset:0
    ds_read_b128 v[104:107], v21 offset:0
    ds_read_b128 v[172:175], v26 offset:0
    ds_read_b128 v[108:111], v22 offset:0
    ds_read_b128 v[176:179], v27 offset:0
    ds_read_b128 v[112:115], v23 offset:0
    ds_read_b128 v[180:183], v24 offset:256
    ds_read_b128 v[116:119], v20 offset:256
    ds_read_b128 v[184:187], v25 offset:256
    ds_read_b128 v[120:123], v21 offset:256
    ds_read_b128 v[188:191], v26 offset:256
    ds_read_b128 v[124:127], v22 offset:256
    ds_read_b128 v[192:195], v27 offset:256
    ds_read_b128 v[128:131], v23 offset:256
    s_waitcnt lgkmcnt(8)
    v_mfma_f32_16x16x32_bf16 v[28:31], v[36:39], v[164:167], 0
    v_mfma_f32_16x16x32_bf16 v[32:35], v[100:103], v[164:167], 0
    v_mfma_f32_16x16x32_bf16 v[28:31], v[40:43], v[168:171], v[28:31]
    v_mfma_f32_16x16x32_bf16 v[32:35], v[104:107], v[168:171], v[32:35]
    v_mfma_f32_16x16x32_bf16 v[28:31], v[44:47], v[172:175], v[28:31]
    v_mfma_f32_16x16x32_bf16 v[32:35], v[108:111], v[172:175], v[32:35]
    v_mfma_f32_16x16x32_bf16 v[28:31], v[48:51], v[176:179], v[28:31]
    v_mfma_f32_16x16x32_bf16 v[32:35], v[112:115], v[176:179], v[32:35]
    ds_read_b128 v[164:167], v24 offset:512
    ds_read_b128 v[132:135], v20 offset:512
    ds_read_b128 v[168:171], v25 offset:512
    ds_read_b128 v[136:139], v21 offset:512
    ds_read_b128 v[172:175], v26 offset:512
    ds_read_b128 v[140:143], v22 offset:512
    ds_read_b128 v[176:179], v27 offset:512
    ds_read_b128 v[144:147], v23 offset:512
    s_waitcnt lgkmcnt(8)
    v_mfma_f32_16x16x32_bf16 v[28:31], v[52:55], v[180:183], v[28:31]
    v_mfma_f32_16x16x32_bf16 v[32:35], v[116:119], v[180:183], v[32:35]
    v_mfma_f32_16x16x32_bf16 v[28:31], v[56:59], v[184:187], v[28:31]
    v_mfma_f32_16x16x32_bf16 v[32:35], v[120:123], v[184:187], v[32:35]
    v_mfma_f32_16x16x32_bf16 v[28:31], v[60:63], v[188:191], v[28:31]
    v_mfma_f32_16x16x32_bf16 v[32:35], v[124:127], v[188:191], v[32:35]
    v_mfma_f32_16x16x32_bf16 v[28:31], v[64:67], v[192:195], v[28:31]
    v_mfma_f32_16x16x32_bf16 v[32:35], v[128:131], v[192:195], v[32:35]
    ds_read_b128 v[180:183], v24 offset:768
    ds_read_b128 v[148:151], v20 offset:768
    ds_read_b128 v[184:187], v25 offset:768
    ds_read_b128 v[152:155], v21 offset:768
    ds_read_b128 v[188:191], v26 offset:768
    ds_read_b128 v[156:159], v22 offset:768
    ds_read_b128 v[192:195], v27 offset:768
    ds_read_b128 v[160:163], v23 offset:768
    s_waitcnt lgkmcnt(8)
    v_mfma_f32_16x16x32_bf16 v[28:31], v[68:71], v[164:167], v[28:31]
    v_mfma_f32_16x16x32_bf16 v[32:35], v[132:135], v[164:167], v[32:35]
    v_mfma_f32_16x16x32_bf16 v[28:31], v[72:75], v[168:171], v[28:31]
    v_mfma_f32_16x16x32_bf16 v[32:35], v[136:139], v[168:171], v[32:35]
    v_mfma_f32_16x16x32_bf16 v[28:31], v[76:79], v[172:175], v[28:31]
    v_mfma_f32_16x16x32_bf16 v[32:35], v[140:143], v[172:175], v[32:35]
    v_mfma_f32_16x16x32_bf16 v[28:31], v[80:83], v[176:179], v[28:31]
    v_mfma_f32_16x16x32_bf16 v[32:35], v[144:147], v[176:179], v[32:35]
    s_waitcnt lgkmcnt(0)
    v_mfma_f32_16x16x32_bf16 v[28:31], v[84:87], v[180:183], v[28:31]
    v_mfma_f32_16x16x32_bf16 v[32:35], v[148:151], v[180:183], v[32:35]
    v_mfma_f32_16x16x32_bf16 v[28:31], v[88:91], v[184:187], v[28:31]
    v_mfma_f32_16x16x32_bf16 v[32:35], v[152:155], v[184:187], v[32:35]
    v_mfma_f32_16x16x32_bf16 v[28:31], v[92:95], v[188:191], v[28:31]
    v_mfma_f32_16x16x32_bf16 v[32:35], v[156:159], v[188:191], v[32:35]
    v_mfma_f32_16x16x32_bf16 v[28:31], v[96:99], v[192:195], v[28:31]
    v_mfma_f32_16x16x32_bf16 v[32:35], v[160:163], v[192:195], v[32:35]
Lsd_25:
    s_nop 7
    v_lshlrev_b32 v196, 4, v2
    s_lshl_b32 s69, s66, 2
    v_add_u32 v197, s69, v196
    v_add_u32 v198, 148608, v197
    v_max3_f32 v164, v28, v29, v30
    v_max3_f32 v165, v31, v32, v33
    v_max3_f32 v164, v164, v34, v35
    v_max_f32 v164, v164, v165
    v_mov_b32 v165, v164
    s_nop 1
    v_permlane16_swap_b32 v164, v165
    v_max_f32 v164, v164, v165
    v_mov_b32 v165, v164
    s_nop 1
    v_permlane32_swap_b32 v164, v165
    v_max_f32 v164, v164, v165
    s_mov_b64 exec, 0xffff
    ds_write_b32 v198, v164
    s_mov_b64 exec, -1
    ds_read_b64_tr_b16 v[36:37], v208 offset:0
    ds_read_b64_tr_b16 v[38:39], v208 offset:16384
    ds_read_b64_tr_b16 v[40:41], v209 offset:0
    ds_read_b64_tr_b16 v[42:43], v209 offset:16384
    ds_read_b64_tr_b16 v[44:45], v210 offset:0
    ds_read_b64_tr_b16 v[46:47], v210 offset:16384
    ds_read_b64_tr_b16 v[48:49], v211 offset:0
    ds_read_b64_tr_b16 v[50:51], v211 offset:16384
    v_add_u32 v198, 148608, v196
    s_waitcnt lgkmcnt(8)
    s_barrier
    ds_read_b128 v[200:203], v198
    ds_read_b64_tr_b16 v[52:53], v208 offset:32768
    ds_read_b64_tr_b16 v[54:55], v208 offset:49152
    ds_read_b64_tr_b16 v[56:57], v209 offset:32768
    ds_read_b64_tr_b16 v[58:59], v209 offset:49152
    ds_read_b64_tr_b16 v[60:61], v210 offset:32768
    ds_read_b64_tr_b16 v[62:63], v210 offset:49152
    ds_read_b64_tr_b16 v[64:65], v211 offset:32768
    ds_read_b64_tr_b16 v[66:67], v211 offset:49152
    s_mov_b32 s70, 0x3e0293ee
    s_waitcnt lgkmcnt(8)
    v_max3_f32 v164, v200, v201, v202
    v_max_f32 v164, v164, v203
    v_mul_f32 v164, s70, v164
    v_fma_f32 v166, v28, s70, -v164
    v_fma_f32 v170, v32, s70, -v164
    v_fma_f32 v167, v29, s70, -v164
    v_fma_f32 v171, v33, s70, -v164
    v_fma_f32 v168, v30, s70, -v164
    v_fma_f32 v172, v34, s70, -v164
    v_fma_f32 v169, v31, s70, -v164
    v_fma_f32 v173, v35, s70, -v164
    v_exp_f32 v166, v166
    v_exp_f32 v167, v167
    v_exp_f32 v168, v168
    v_exp_f32 v169, v169
    v_exp_f32 v170, v170
    v_exp_f32 v171, v171
    v_exp_f32 v172, v172
    v_exp_f32 v173, v173
    s_lshr_b32 s69, s66, 1
    s_lshl_b32 s69, s69, 10
    s_and_b32 s71, s66, 1
    s_lshl_b32 s71, s71, 3
    s_add_u32 s69, s69, s71
    s_add_u32 s69, s69, 151040
    v_add_u32 v202, s69, v6
    v_add_f32 v165, v166, v167
    v_add_f32 v200, v168, v169
    v_add_f32 v201, v170, v171
    v_add_f32 v203, v172, v173
    v_cvt_pk_bf16_f32 v166, v166, v167
    v_cvt_pk_bf16_f32 v167, v168, v169
    v_cvt_pk_bf16_f32 v168, v170, v171
    v_cvt_pk_bf16_f32 v169, v172, v173
    ds_write_b64 v202, v[166:167]
    ds_write_b64 v202, v[168:169] offset:2048
    v_add_f32 v165, v165, v200
    v_add_f32 v201, v201, v203
    v_add_f32 v165, v165, v201
    v_mov_b32 v200, v165
    s_nop 1
    v_permlane16_swap_b32 v165, v200
    v_add_f32 v165, v165, v200
    v_mov_b32 v200, v165
    s_nop 1
    v_permlane32_swap_b32 v165, v200
    v_add_f32 v165, v165, v200
    v_add_u32 v198, 149120, v197
    v_lshlrev_b32 v199, 2, v2
    v_add_u32 v199, 149376, v199
    s_mov_b64 exec, 0xffff
    ds_write_b32 v198, v165
    ds_write_b32 v199, v164
    s_mov_b64 exec, -1
    s_waitcnt lgkmcnt(0)
    s_barrier
    v_add_u32 v202, 151040, v6
    ds_read_b128 v[100:103], v202 offset:0
    ds_read_b128 v[104:107], v202 offset:1024
    ds_read_b128 v[108:111], v202 offset:2048
    ds_read_b128 v[112:115], v202 offset:3072
    v_lshlrev_b32 v196, 4, v2
    v_add_u32 v198, 149120, v196
    v_lshlrev_b32 v199, 2, v2
    v_add_u32 v199, 149376, v199
    ds_read_b128 v[132:135], v198
    ds_read_b32 v148, v199
    ds_read_b64_tr_b16 v[68:69], v212 offset:0
    ds_read_b64_tr_b16 v[70:71], v212 offset:16384
    ds_read_b64_tr_b16 v[72:73], v213 offset:0
    ds_read_b64_tr_b16 v[74:75], v213 offset:16384
    ds_read_b64_tr_b16 v[76:77], v214 offset:0
    ds_read_b64_tr_b16 v[78:79], v214 offset:16384
    ds_read_b64_tr_b16 v[80:81], v215 offset:0
    ds_read_b64_tr_b16 v[82:83], v215 offset:16384
    s_waitcnt lgkmcnt(13)
    v_mfma_f32_16x16x32_bf16 v[116:119], v[36:39], v[100:103], 0
    v_mfma_f32_16x16x32_bf16 v[120:123], v[40:43], v[100:103], 0
    v_mfma_f32_16x16x32_bf16 v[124:127], v[44:47], v[100:103], 0
    v_mfma_f32_16x16x32_bf16 v[128:131], v[48:51], v[100:103], 0
    s_waitcnt lgkmcnt(12)
    v_mfma_f32_16x16x32_bf16 v[116:119], v[52:55], v[104:107], v[116:119]
    v_mfma_f32_16x16x32_bf16 v[120:123], v[56:59], v[104:107], v[120:123]
    v_mfma_f32_16x16x32_bf16 v[124:127], v[60:63], v[104:107], v[124:127]
    v_mfma_f32_16x16x32_bf16 v[128:131], v[64:67], v[104:107], v[128:131]
    ds_read_b64_tr_b16 v[84:85], v212 offset:32768
    ds_read_b64_tr_b16 v[86:87], v212 offset:49152
    ds_read_b64_tr_b16 v[88:89], v213 offset:32768
    ds_read_b64_tr_b16 v[90:91], v213 offset:49152
    ds_read_b64_tr_b16 v[92:93], v214 offset:32768
    ds_read_b64_tr_b16 v[94:95], v214 offset:49152
    ds_read_b64_tr_b16 v[96:97], v215 offset:32768
    ds_read_b64_tr_b16 v[98:99], v215 offset:49152
    s_waitcnt lgkmcnt(8)
    v_mfma_f32_16x16x32_bf16 v[116:119], v[68:71], v[108:111], v[116:119]
    v_mfma_f32_16x16x32_bf16 v[120:123], v[72:75], v[108:111], v[120:123]
    v_mfma_f32_16x16x32_bf16 v[124:127], v[76:79], v[108:111], v[124:127]
    v_mfma_f32_16x16x32_bf16 v[128:131], v[80:83], v[108:111], v[128:131]
    s_waitcnt lgkmcnt(0)
    v_mfma_f32_16x16x32_bf16 v[116:119], v[84:87], v[112:115], v[116:119]
    v_mfma_f32_16x16x32_bf16 v[120:123], v[88:91], v[112:115], v[120:123]
    v_mfma_f32_16x16x32_bf16 v[124:127], v[92:95], v[112:115], v[124:127]
    v_mfma_f32_16x16x32_bf16 v[128:131], v[96:99], v[112:115], v[128:131]
    s_branch L_att3
L_sw_att:
    s_cmp_eq_u32 s65, 0
    s_cbranch_scc1 Lnb_26
    s_add_u32 s5, s81, 22016
    buffer_load_dwordx4 v[224:227], v219, s[28:31], s81 offen nt
    buffer_load_dwordx4 v[228:231], v219, s[28:31], s5 offen nt
    buffer_load_dwordx4 v[232:235], v219, s[32:35], s81 offen nt
    buffer_load_dwordx4 v[236:239], v219, s[32:35], s5 offen nt
Lnb_26:
    ds_read_b64_tr_b16 v[36:37], v208 offset:0
    ds_read_b64_tr_b16 v[38:39], v208 offset:16384
    ds_read_b64_tr_b16 v[40:41], v209 offset:0
    ds_read_b64_tr_b16 v[42:43], v209 offset:16384
    ds_read_b64_tr_b16 v[44:45], v210 offset:0
    ds_read_b64_tr_b16 v[46:47], v210 offset:16384
    ds_read_b64_tr_b16 v[48:49], v211 offset:0
    ds_read_b64_tr_b16 v[50:51], v211 offset:16384
    ds_read_b64_tr_b16 v[52:53], v208 offset:32768
    ds_read_b64_tr_b16 v[54:55], v208 offset:49152
    ds_read_b64_tr_b16 v[56:57], v209 offset:32768
    ds_read_b64_tr_b16 v[58:59], v209 offset:49152
    ds_read_b64_tr_b16 v[60:61], v210 offset:32768
    ds_read_b64_tr_b16 v[62:63], v210 offset:49152
    ds_read_b64_tr_b16 v[64:65], v211 offset:32768
    ds_read_b64_tr_b16 v[66:67], v211 offset:49152
    s_barrier
    s_lshl_b32 s4, s66, 12
    s_add_u32 m0, s4, 131072
    s_add_u32 s5, s80, 0
    buffer_load_dwordx4 v217, s[20:23], s5 offen nt lds
    s_add_u32 m0, s4, 132096
    s_add_u32 s5, s80, 32768
    buffer_load_dwordx4 v218, s[20:23], s5 offen nt lds
    s_add_u32 m0, s4, 133120
    s_add_u32 s5, s80, 65536
    buffer_load_dwordx4 v217, s[20:23], s5 offen nt lds
    s_add_u32 m0, s4, 134144
    s_add_u32 s5, s80, 98304
    buffer_load_dwordx4 v218, s[20:23], s5 offen nt lds
    ds_read_b64_tr_b16 v[68:69], v212 offset:0
    ds_read_b64_tr_b16 v[70:71], v212 offset:16384
    ds_read_b64_tr_b16 v[72:73], v213 offset:0
    ds_read_b64_tr_b16 v[74:75], v213 offset:16384
    ds_read_b64_tr_b16 v[76:77], v214 offset:0
    ds_read_b64_tr_b16 v[78:79], v214 offset:16384
    ds_read_b64_tr_b16 v[80:81], v215 offset:0
    ds_read_b64_tr_b16 v[82:83], v215 offset:16384
    ds_read_b64_tr_b16 v[84:85], v212 offset:32768
    ds_read_b64_tr_b16 v[86:87], v212 offset:49152
    ds_read_b64_tr_b16 v[88:89], v213 offset:32768
    ds_read_b64_tr_b16 v[90:91], v213 offset:49152
    ds_read_b64_tr_b16 v[92:93], v214 offset:32768
    ds_read_b64_tr_b16 v[94:95], v214 offset:49152
    ds_read_b64_tr_b16 v[96:97], v215 offset:32768
    ds_read_b64_tr_b16 v[98:99], v215 offset:49152
    s_barrier
    v_add_u32 v202, 151040, v6
    ds_read_b128 v[100:103], v202 offset:0
    ds_read_b128 v[104:107], v202 offset:1024
    ds_read_b128 v[108:111], v202 offset:2048
    ds_read_b128 v[112:115], v202 offset:3072
    v_lshlrev_b32 v196, 4, v2
    v_add_u32 v198, 149120, v196
    v_lshlrev_b32 v199, 2, v2
    v_add_u32 v199, 149376, v199
    ds_read_b128 v[132:135], v198
    ds_read_b32 v148, v199
    s_waitcnt lgkmcnt(5)
    v_mfma_f32_16x16x32_bf16 v[116:119], v[36:39], v[100:103], 0
    v_mfma_f32_16x16x32_bf16 v[120:123], v[40:43], v[100:103], 0
    v_mfma_f32_16x16x32_bf16 v[124:127], v[44:47], v[100:103], 0
    v_mfma_f32_16x16x32_bf16 v[128:131], v[48:51], v[100:103], 0
    s_waitcnt lgkmcnt(4)
    v_mfma_f32_16x16x32_bf16 v[116:119], v[52:55], v[104:107], v[116:119]
    v_mfma_f32_16x16x32_bf16 v[120:123], v[56:59], v[104:107], v[120:123]
    v_mfma_f32_16x16x32_bf16 v[124:127], v[60:63], v[104:107], v[124:127]
    v_mfma_f32_16x16x32_bf16 v[128:131], v[64:67], v[104:107], v[128:131]
    s_waitcnt lgkmcnt(3)
    v_mfma_f32_16x16x32_bf16 v[116:119], v[68:71], v[108:111], v[116:119]
    v_mfma_f32_16x16x32_bf16 v[120:123], v[72:75], v[108:111], v[120:123]
    v_mfma_f32_16x16x32_bf16 v[124:127], v[76:79], v[108:111], v[124:127]
    v_mfma_f32_16x16x32_bf16 v[128:131], v[80:83], v[108:111], v[128:131]
    s_waitcnt lgkmcnt(2)
    v_mfma_f32_16x16x32_bf16 v[116:119], v[84:87], v[112:115], v[116:119]
    v_mfma_f32_16x16x32_bf16 v[120:123], v[88:91], v[112:115], v[120:123]
    v_mfma_f32_16x16x32_bf16 v[124:127], v[92:95], v[112:115], v[124:127]
    v_mfma_f32_16x16x32_bf16 v[128:131], v[96:99], v[112:115], v[128:131]
L_att3:
    v_lshlrev_b32 v196, 17, v2
    v_and_b32 v197, 1, v3
    v_lshlrev_b32 v197, 5, v197
    v_lshrrev_b32 v198, 1, v3
    v_lshl_add_u32 v197, v198, 4, v197
    v_add_u32 v196, v196, v197
    s_lshl_b32 s69, s60, 21
    s_lshl_b32 s70, s3, 14
    s_add_u32 s69, s69, s70
    s_lshl_b32 s70, s61, 13
    s_add_u32 s69, s69, s70
    s_lshl_b32 s70, s62, 7
    s_add_u32 s69, s69, s70
    s_add_u32 s69, s69, 4194304
    v_lshlrev_b32 v199, 6, v2
    s_lshl_b32 s68, s3, 2
    s_add_u32 s68, s68, 149648
    v_add_u32 v200, s68, v199
    v_add_u32 v199, 149632, v199
    s_waitcnt lgkmcnt(0)
    v_pk_add_f32 v[132:133], v[132:133], v[134:135]
    v_add_f32 v149, v132, v133
    v_cvt_pk_bf16_f32 v156, v116, v117
    v_cvt_pk_bf16_f32 v157, v118, v119
    v_cvt_pk_bf16_f32 v158, v120, v121
    v_cvt_pk_bf16_f32 v159, v122, v123
    v_cvt_pk_bf16_f32 v160, v124, v125
    v_cvt_pk_bf16_f32 v161, v126, v127
    v_cvt_pk_bf16_f32 v162, v128, v129
    v_cvt_pk_bf16_f32 v163, v130, v131
    v_add3_u32 v150, v156, v157, v158
    v_add3_u32 v151, v159, v160, v161
    v_add3_u32 v150, v150, v162, v163
    v_permlane16_swap_b32 v156, v158
    v_permlane16_swap_b32 v157, v159
    v_permlane16_swap_b32 v160, v162
    v_permlane16_swap_b32 v161, v163
    s_cmp_lg_u32 s3, 7
    s_cbranch_scc1 Lad_27
    s_lshl_b32 s68, s60, 13
    s_and_b32 s4, s62, 3
    s_lshl_b32 s4, s4, 7
    s_add_u32 s68, s68, s4
    s_add_u32 s68, s68, 3670016
    v_lshlrev_b32 v203, 9, v1
    s_mov_b64 exec, 0xffff
    buffer_atomic_add v11, v203, s[40:43], s68 offen sc1
    s_mov_b64 exec, -1
Lad_27:
    buffer_store_dwordx4 v[156:159], v196, s[40:43], s69 offen sc1
    buffer_store_dwordx4 v[160:163], v196, s[40:43], s69 offen offset:64 sc1
    v_add_u32 v150, v150, v151
    v_mov_b32 v151, v150
    s_nop 1
    v_permlane16_swap_b32 v150, v151
    v_add_u32 v150, v150, v151
    v_mov_b32 v151, v150
    s_nop 1
    v_permlane32_swap_b32 v150, v151
    v_add_u32 v150, v150, v151
    v_add_u32 v151, v150, v4
    v_add3_u32 v150, v148, v149, v4
    s_mov_b64 exec, 0xffff
    ds_write_b32 v200, v151
    ds_write_b96 v199, v[148:150]
    s_mov_b64 exec, 1
    ds_add_rtn_u32 v201, v10, v11 offset:24
    s_mov_b64 exec, -1
    s_waitcnt lgkmcnt(0)
    v_readfirstlane_b32 s71, v201
    s_mov_b32 s77, 0
    s_cmp_lg_u32 s71, 7
    s_cbranch_scc1 Lnl_28
    v_add_u32 v202, 149632, v6
    ds_read_b128 v[152:155], v202
    v_lshrrev_b32 v203, 2, v1
    v_lshlrev_b32 v203, 13, v203
    v_and_b32 v204, 3, v1
    v_lshl_add_u32 v203, v204, 4, v203
    s_lshl_b32 s68, s60, 17
    s_lshl_b32 s70, s61, 12
    s_add_u32 s68, s68, s70
    s_lshl_b32 s70, s62, 6
    s_add_u32 s68, s68, s70
    s_add_u32 s68, s68, 3145728
    s_waitcnt lgkmcnt(0)
    buffer_store_dwordx4 v[152:155], v203, s[40:43], s68 offen sc1
    s_mov_b32 s77, 1
Lnl_28:
    v_lshrrev_b32 v196, 2, v2
    v_lshl_add_u32 v196, v3, 3, v196
    v_and_b32 v197, 1, v2
    v_lshlrev_b32 v197, 3, v197
    v_bfe_u32 v198, v2, 1, 1
    v_mov_b32 v70, v196
    v_mov_b32 v71, v197
    v_mov_b32 v72, v198
    v_lshlrev_b32 v74, 4, v3
    v_lshrrev_b32 v13, 3, v1
    v_lshlrev_b32 v12, 10, v13
    v_and_b32 v196, 7, v1
    v_lshl_add_u32 v12, v196, 4, v12
    v_lshlrev_b32 v13, 9, v13
    s_barrier
    s_cmp_eq_u32 s65, 0
    s_cbranch_scc1 Lsw_29
    s_cmp_lt_u32 s3, 4
    s_cbranch_scc1 Lsw_29
    s_lshl_b32 s4, s66, 11
    v_add_u32 v196, s4, v6
    s_waitcnt vmcnt(6)
    ds_write_b128 v196, v[224:227] offset:0
    ds_write_b128 v196, v[228:231] offset:1024
    ds_write_b128 v196, v[232:235] offset:8192
    ds_write_b128 v196, v[236:239] offset:9216
Lsw_29:
    s_lshl_b32 s4, s3, 10
    s_cmp_eq_u32 s65, 0
    s_cbranch_scc1 Lnb_30
    s_add_u32 m0, s4, 16384
    s_nop 0
    buffer_load_dwordx4 v216, s[36:39], s83 offen nt lds
Lnb_30:
    s_lshl_b32 s4, s3, 11
    s_add_u32 m0, s4, 24576
    s_add_u32 s5, s82, 8192
    buffer_load_dwordx4 v216, s[24:27], s82 offen nt lds
    s_add_u32 m0, s4, 25600
    s_nop 0
    buffer_load_dwordx4 v216, s[24:27], s5 offen nt lds
    s_cmp_eq_u32 s65, 0
    s_cbranch_scc1 Lnb1_31
    s_and_b32 s84, s3, 3
    s_lshr_b32 s68, s3, 2
    s_lshl_b32 s68, s68, 13
    s_add_u32 s68, s68, 0
    v_add_u32 v196, 0, v70
    v_bfe_u32 v197, v196, 1, 2
    v_lshlrev_b32 v197, 1, v197
    s_lshl_b32 s69, s84, 1
    v_add_u32 v198, s69, v72
    v_xor_b32 v198, v198, v197
    v_lshlrev_b32 v196, 7, v196
    v_lshl_add_u32 v76, v198, 4, v196
    v_add_u32 v76, v76, v71
    v_add_u32 v76, s68, v76
    v_add_u32 v196, 4, v70
    v_bfe_u32 v197, v196, 1, 2
    v_lshlrev_b32 v197, 1, v197
    s_lshl_b32 s69, s84, 1
    v_add_u32 v198, s69, v72
    v_xor_b32 v198, v198, v197
    v_lshlrev_b32 v196, 7, v196
    v_lshl_add_u32 v77, v198, 4, v196
    v_add_u32 v77, v77, v71
    v_add_u32 v77, s68, v77
    v_and_b32 v78, 1, v1
    v_lshl_add_u32 v78, v78, 7, v74
    v_add_u32 v78, 150656, v78
    s_waitcnt lgkmcnt(0)
    s_barrier
    ds_read_b128 v[32:35], v78 offset:0
    ds_read_b64_tr_b16 v[48:49], v76 offset:0
    ds_read_b64_tr_b16 v[50:51], v77 offset:0
    ds_read_b128 v[36:39], v78 offset:64
    ds_read_b64_tr_b16 v[52:53], v76 offset:4096
    ds_read_b64_tr_b16 v[54:55], v77 offset:4096
    s_waitcnt lgkmcnt(3)
    v_mfma_f32_16x16x32_bf16 v[64:67], v[32:35], v[48:51], 0
    s_waitcnt lgkmcnt(0)
    v_mfma_f32_16x16x32_bf16 v[64:67], v[36:39], v[52:55], v[64:67]
    s_lshl_b32 s68, s72, 10
    s_lshl_b32 s69, s3, 7
    s_add_u32 s68, s68, s69
    s_add_u32 s68, s68, 2097152
    s_lshl_b32 s70, s72, 9
    s_lshl_b32 s69, s3, 6
    s_add_u32 s70, s70, s69
    s_add_u32 s70, s70, 2359296
    v_add_u32 v196, v64, v65
    v_lshlrev_b32 v197, 3, v2
    v_add_u32 v81, s68, v197
    v_and_b32 v197, 0x38, v197
    v_add_u32 v197, s70, v197
    v_add_u32_dpp v196, v196, v196 row_ror:8 row_mask:0xf bank_mask:0xf
    s_nop 1
    v_add_u32_dpp v196, v196, v196 row_ror:4 row_mask:0xf bank_mask:0xf
    s_nop 1
    v_add_u32_dpp v196, v196, v196 row_ror:2 row_mask:0xf bank_mask:0xf
    s_nop 1
    v_add_u32_dpp v196, v196, v196 row_ror:1 row_mask:0xf bank_mask:0xf
    v_cmp_gt_u32 vcc, 16, v1
    v_add_u32 v196, v196, v4
    s_nop 0
    v_cndmask_b32 v81, v197, v81, vcc
    v_cndmask_b32 v68, v196, v64, vcc
    v_cndmask_b32 v69, v196, v65, vcc
    s_mov_b64 exec, 0xffffff
    s_mov_b32 s71, 8388608
    buffer_store_dwordx2 v[68:69], v81, s[40:43], s71 offen
    s_mov_b64 exec, -1
    s_mov_b64 exec, 0xffffff
    buffer_store_dwordx2 v[68:69], v81, s[40:43], 0 offen sc1
    s_mov_b64 exec, -1
Lnb1_31:
    s_and_b32 s84, s3, 3
    s_lshr_b32 s85, s3, 2
    s_lshl_b32 s68, s85, 13
    s_add_u32 s68, s68, 40960
    v_add_u32 v196, 0, v70
    v_bfe_u32 v197, v196, 1, 2
    v_lshlrev_b32 v197, 1, v197
    s_lshl_b32 s69, s84, 1
    v_add_u32 v198, s69, v72
    v_xor_b32 v198, v198, v197
    v_lshlrev_b32 v196, 7, v196
    v_lshl_add_u32 v76, v198, 4, v196
    v_add_u32 v76, v76, v71
    v_add_u32 v76, s68, v76
    v_add_u32 v196, 4, v70
    v_bfe_u32 v197, v196, 1, 2
    v_lshlrev_b32 v197, 1, v197
    s_lshl_b32 s69, s84, 1
    v_add_u32 v198, s69, v72
    v_xor_b32 v198, v198, v197
    v_lshlrev_b32 v196, 7, v196
    v_lshl_add_u32 v77, v198, 4, v196
    v_add_u32 v77, v77, v71
    v_add_u32 v77, s68, v77
    s_lshl_b32 s68, s85, 7
    s_add_u32 s68, s68, 148608
    v_add_u32 v78, s68, v74
    s_mov_b32 s68, 131072
    v_add_u32 v196, 0, v70
    v_and_b32 v197, 7, v196
    v_lshlrev_b32 v197, 1, v197
    s_lshl_b32 s69, s3, 1
    v_add_u32 v198, s69, v72
    v_xor_b32 v198, v198, v197
    v_lshlrev_b32 v196, 8, v196
    v_lshl_add_u32 v110, v198, 4, v196
    v_add_u32 v110, v110, v71
    v_add_u32 v110, s68, v110
    v_add_u32 v196, 4, v70
    v_and_b32 v197, 7, v196
    v_lshlrev_b32 v197, 1, v197
    s_lshl_b32 s69, s3, 1
    v_add_u32 v198, s69, v72
    v_xor_b32 v198, v198, v197
    v_lshlrev_b32 v196, 8, v196
    v_lshl_add_u32 v111, v198, 4, v196
    v_add_u32 v111, v111, v71
    v_add_u32 v111, s68, v111
    v_and_b32 v119, 1, v1
    v_lshl_add_u32 v112, v119, 7, v74
    v_add_u32 v118, 149120, v112
    v_add_u32 v112, 148864, v112
    s_mov_b32 s68, 24576
    v_add_u32 v196, 0, v70
    v_bfe_u32 v197, v196, 1, 2
    v_lshlrev_b32 v197, 1, v197
    s_lshl_b32 s69, s84, 1
    v_add_u32 v198, s69, v72
    v_xor_b32 v198, v198, v197
    v_lshlrev_b32 v196, 7, v196
    v_lshl_add_u32 v113, v198, 4, v196
    v_add_u32 v113, v113, v71
    v_add_u32 v113, s68, v113
    v_add_u32 v196, 4, v70
    v_bfe_u32 v197, v196, 1, 2
    v_lshlrev_b32 v197, 1, v197
    s_lshl_b32 s69, s84, 1
    v_add_u32 v198, s69, v72
    v_xor_b32 v198, v198, v197
    v_lshlrev_b32 v196, 7, v196
    v_lshl_add_u32 v114, v198, 4, v196
    v_add_u32 v114, v114, v71
    v_add_u32 v114, s68, v114
    v_lshl_add_u32 v115, v119, 8, v74
    v_add_u32 v115, 147968, v115
    s_mov_b32 s68, 16384
    v_add_u32 v196, 0, v70
    v_bfe_u32 v197, v196, 1, 2
    v_lshlrev_b32 v197, 1, v197
    s_lshl_b32 s69, s84, 1
    v_add_u32 v198, s69, v72
    v_xor_b32 v198, v198, v197
    v_lshlrev_b32 v196, 7, v196
    v_lshl_add_u32 v116, v198, 4, v196
    v_add_u32 v116, v116, v71
    v_add_u32 v116, s68, v116
    v_add_u32 v196, 4, v70
    v_bfe_u32 v197, v196, 1, 2
    v_lshlrev_b32 v197, 1, v197
    s_lshl_b32 s69, s84, 1
    v_add_u32 v198, s69, v72
    v_xor_b32 v198, v198, v197
    v_lshlrev_b32 v196, 7, v196
    v_lshl_add_u32 v117, v198, 4, v196
    v_add_u32 v117, v117, v71
    v_add_u32 v117, s68, v117
    s_lshl_b32 s86, s72, 14
    s_lshl_b32 s70, s3, 10
    s_add_u32 s86, s86, s70
    s_add_u32 s86, s86, 4194304
    s_add_u32 s87, s86, 8192
    s_lshl_b32 s88, s59, 13
    s_add_u32 s88, s88, 3145728
    s_lshl_b32 s70, s3, 9
    s_add_u32 s89, s88, s70
    s_lshl_b32 s70, s58, 2
    s_add_u32 s89, s89, s70
    s_add_u32 s89, s89, 16
    s_add_u32 s90, s89, 4096
    s_lshl_b32 s70, s85, 12
    s_add_u32 s91, s88, s70
    v_lshrrev_b32 v9, 3, v1
    v_lshlrev_b32 v9, 6, v9
    v_lshlrev_b32 v8, 6, v1
    s_lshl_b32 s92, s3, 10
    s_add_u32 s92, s92, 40960
    v_add_u32 v7, s92, v6
    s_cmp_lg_u32 s3, 2
    s_cbranch_scc1 Lcw_32
    s_lshl_b32 s71, s59, 9
    s_add_u32 s71, s71, 3670016
    s_mov_b32 s98, 0
    v_mov_b32 v209, 32
    v_lshlrev_b32 v208, 7, v1
    s_mov_b64 exec, 15
    v_mov_b32 v210, 0
    buffer_atomic_or v210, v208, s[40:43], s71 offen sc0 sc1
    s_sleep 5
    v_mov_b32 v211, 0
    buffer_atomic_or v211, v208, s[40:43], s71 offen sc0 sc1
    s_sleep 5
    v_mov_b32 v212, 0
    buffer_atomic_or v212, v208, s[40:43], s71 offen sc0 sc1
    s_sleep 5
Lcwp_33:
    v_mov_b32 v213, 0
    buffer_atomic_or v213, v208, s[40:43], s71 offen sc0 sc1
    s_waitcnt vmcnt(3)
    v_cmp_ne_u32 vcc, v209, v210
    s_cbranch_vccz Lcwo_34
    s_sleep 5
    v_mov_b32 v210, 0
    buffer_atomic_or v210, v208, s[40:43], s71 offen sc0 sc1
    s_waitcnt vmcnt(3)
    v_cmp_ne_u32 vcc, v209, v211
    s_cbranch_vccz Lcwo_34
    s_sleep 5
    v_mov_b32 v211, 0
    buffer_atomic_or v211, v208, s[40:43], s71 offen sc0 sc1
    s_waitcnt vmcnt(3)
    v_cmp_ne_u32 vcc, v209, v212
    s_cbranch_vccz Lcwo_34
    s_sleep 5
    v_mov_b32 v212, 0
    buffer_atomic_or v212, v208, s[40:43], s71 offen sc0 sc1
    s_waitcnt vmcnt(3)
    v_cmp_ne_u32 vcc, v209, v213
    s_cbranch_vccz Lcwo_34
    s_sleep 5
    s_add_u32 s98, s98, 1
    s_cmp_lt_u32 s98, 200000
    s_cbranch_scc1 Lcwp_33
    s_or_b32 s99, s99, 64
Lcwo_34:
    s_mov_b64 exec, -1
Lcw_32:
    s_barrier
    s_mov_b32 s98, 0
Lg3_35:
    s_mov_b32 m0, s92
    s_nop 0
    buffer_load_dwordx4 v220, s[40:43], s86 offen sc1 lds
    s_add_u32 m0, s92, 8192
    s_nop 0
    buffer_load_dwordx4 v220, s[40:43], s87 offen sc1 lds
    buffer_load_dword v24, v9, s[40:43], s89 offen sc1
    buffer_load_dword v25, v9, s[40:43], s90 offen sc1
    s_cmp_lg_u32 s84, 0
    s_cbranch_scc1 Lg3t_38
    buffer_load_dwordx3 v[80:82], v8, s[40:43], s91 offen sc1
Lg3t_38:
    s_waitcnt vmcnt(0)
    ds_read_b128 v[16:19], v7
    ds_read_b128 v[20:23], v7 offset:8192
    s_cmp_lg_u32 s84, 0
    s_cbranch_scc1 Lg3a_36
    v_add3_u32 v202, v80, v81, v4
    v_xor_b32 v202, v202, v82
    v_mov_b32 v83, v80
    s_nop 1
    v_max_f32_dpp v83, v83, v83 row_ror:8 row_mask:0xf bank_mask:0xf
    s_nop 1
    v_max_f32_dpp v83, v83, v83 row_ror:4 row_mask:0xf bank_mask:0xf
    s_nop 1
    v_max_f32_dpp v83, v83, v83 row_ror:2 row_mask:0xf bank_mask:0xf
    s_nop 1
    v_max_f32_dpp v83, v83, v83 row_ror:1 row_mask:0xf bank_mask:0xf
    v_mov_b32 v203, v83
    s_nop 1
    v_permlane16_swap_b32 v83, v203
    v_max_f32 v83, v83, v203
    v_mov_b32 v203, v83
    s_nop 1
    v_permlane32_swap_b32 v83, v203
    v_max_f32 v83, v83, v203
    v_sub_f32 v84, v80, v83
    v_exp_f32 v84, v84
    s_branch Lg3b_37
Lg3a_36:
    v_mov_b32 v202, 0
Lg3b_37:
    s_nop 1
    s_waitcnt lgkmcnt(0)
    v_add3_u32 v196, v16, v17, v18
    v_add_u32 v196, v196, v19
    v_add3_u32 v197, v20, v21, v22
    v_add_u32 v197, v197, v23
    v_add_u32_dpp v196, v196, v196 quad_perm:[1,0,3,2] row_mask:0xf bank_mask:0xf
    s_nop 0
    v_add_u32_dpp v197, v197, v197 quad_perm:[1,0,3,2] row_mask:0xf bank_mask:0xf
    v_add_u32_dpp v196, v196, v196 quad_perm:[2,3,0,1] row_mask:0xf bank_mask:0xf
    s_nop 0
    v_add_u32_dpp v197, v197, v197 quad_perm:[2,3,0,1] row_mask:0xf bank_mask:0xf
    v_add_u32_dpp v196, v196, v196 row_half_mirror row_mask:0xf bank_mask:0xf
    s_nop 0
    v_add_u32_dpp v197, v197, v197 row_half_mirror row_mask:0xf bank_mask:0xf
    v_add_u32 v196, v196, v4
    v_add_u32 v197, v197, v4
    v_xor_b32 v196, v196, v24
    v_xor_b32 v197, v197, v25
    v_xor_b32 v202, v202, v5
    v_or3_b32 v196, v196, v197, v202
    v_cmp_ne_u32 vcc, 0, v196
    s_cbranch_vccz Lok_39
    s_add_u32 s98, s98, 1
    s_sleep 6
    s_cmp_lt_u32 s98, 200000
    s_cbranch_scc1 Lg3_35
    s_or_b32 s99, s99, 4
Lok_39:
    s_cmp_eq_u32 s65, 0
    s_cbranch_scc1 Leg_40
    s_cmp_ge_u32 s3, 4
    s_cbranch_scc1 Leg_40
    s_mov_b32 s98, 0
    s_cmp_lt_u32 s98, 12
    s_cselect_b32 s4, 8388608, 0
    s_add_u32 s5, s3, 0
    s_lshl_b32 s6, s59, 13
    s_lshl_b32 s7, s5, 7
    s_add_u32 s6, s6, s7
    s_add_u32 s6, s6, s4
    s_add_u32 s6, s6, 2097152
    s_lshl_b32 s7, s59, 12
    s_lshl_b32 s5, s5, 6
    s_add_u32 s7, s7, s5
    s_add_u32 s7, s7, s4
    s_add_u32 s7, s7, 2359296
    buffer_load_dwordx4 v[100:103], v12, s[40:43], s6 offen sc1
    buffer_load_dword v108, v13, s[40:43], s7 offen sc1
    s_cmp_lt_u32 s98, 12
    s_cselect_b32 s4, 8388608, 0
    s_add_u32 s5, s3, 4
    s_lshl_b32 s6, s59, 13
    s_lshl_b32 s7, s5, 7
    s_add_u32 s6, s6, s7
    s_add_u32 s6, s6, s4
    s_add_u32 s6, s6, 2097152
    s_lshl_b32 s7, s59, 12
    s_lshl_b32 s5, s5, 6
    s_add_u32 s7, s7, s5
    s_add_u32 s7, s7, s4
    s_add_u32 s7, s7, 2359296
    buffer_load_dwordx4 v[104:107], v12, s[40:43], s6 offen sc1
    buffer_load_dword v109, v13, s[40:43], s7 offen sc1
Leg_40:
    s_and_b32 s69, s3, 3
    s_cmp_lg_u32 s69, 0
    s_cbranch_scc1 Lsm_41
    v_cvt_pk_bf16_f32 v85, v84, v84
    s_lshl_b32 s68, s85, 7
    s_add_u32 s68, s68, 148608
    v_lshl_add_u32 v196, v1, 1, s68
    ds_write_b16 v196, v85
    v_lshlrev_b32 v84, 16, v85
    v_mul_f32 v84, v84, v81
    s_nop 1
    v_add_f32_dpp v84, v84, v84 row_ror:8 row_mask:0xf bank_mask:0xf
    s_nop 1
    v_add_f32_dpp v84, v84, v84 row_ror:4 row_mask:0xf bank_mask:0xf
    s_nop 1
    v_add_f32_dpp v84, v84, v84 row_ror:2 row_mask:0xf bank_mask:0xf
    s_nop 1
    v_add_f32_dpp v84, v84, v84 row_ror:1 row_mask:0xf bank_mask:0xf
    v_mov_b32 v203, v84
    s_nop 1
    v_permlane16_swap_b32 v84, v203
    v_add_f32 v84, v84, v203
    v_mov_b32 v203, v84
    s_nop 1
    v_permlane32_swap_b32 v84, v203
    v_add_f32 v84, v84, v203
    v_rcp_f32 v84, v84
    s_lshl_b32 s68, s85, 2
    s_add_u32 s68, s68, 150912
    v_mov_b32 v197, s68
    s_mov_b64 exec, 1
    ds_write_b32 v197, v84
    s_mov_b64 exec, -1
Lsm_41:
    s_lshl_b32 s68, s85, 2
    s_add_u32 s68, s68, 150912
    v_mov_b32 v197, s68
    s_waitcnt lgkmcnt(0)
    s_barrier
    ds_read_b32 v86, v197
    ds_read_b128 v[32:35], v78 offset:0
    ds_read_b64_tr_b16 v[48:49], v76 offset:0
    ds_read_b64_tr_b16 v[50:51], v77 offset:0
    ds_read_b128 v[36:39], v78 offset:64
    ds_read_b64_tr_b16 v[52:53], v76 offset:4096
    ds_read_b64_tr_b16 v[54:55], v77 offset:4096
    s_waitcnt lgkmcnt(3)
    v_mfma_f32_16x16x32_bf16 v[64:67], v[32:35], v[48:51], 0
    s_waitcnt lgkmcnt(0)
    v_mfma_f32_16x16x32_bf16 v[64:67], v[36:39], v[52:55], v[64:67]
    s_lshl_b32 s68, s85, 7
    s_lshl_b32 s69, s84, 5
    s_add_u32 s68, s68, s69
    s_add_u32 s68, s68, 148864
    v_lshl_add_u32 v198, v2, 1, s68
    s_nop 2
    v_mul_f32 v64, v64, v86
    v_cvt_pk_bf16_f32 v64, v64, v64
    s_mov_b64 exec, 0xffff
    ds_write_b16 v198, v64
    s_mov_b64 exec, -1
    s_lshl_b32 s86, s72, 10
    s_lshl_b32 s69, s3, 7
    s_add_u32 s86, s86, s69
    s_add_u32 s86, s86, 1572864
    s_lshl_b32 s87, s72, 9
    s_lshl_b32 s69, s3, 6
    s_add_u32 s87, s87, s69
    s_add_u32 s87, s87, 1835008
    s_waitcnt lgkmcnt(0)
    s_barrier
    ds_read_b128 v[32:35], v112 offset:0
    ds_read_b64_tr_b16 v[48:49], v110 offset:0
    ds_read_b64_tr_b16 v[50:51], v111 offset:0
    ds_read_b128 v[36:39], v112 offset:64
    ds_read_b64_tr_b16 v[52:53], v110 offset:8192
    ds_read_b64_tr_b16 v[54:55], v111 offset:8192
    s_waitcnt lgkmcnt(3)
    v_mfma_f32_16x16x32_bf16 v[64:67], v[32:35], v[48:51], 0
    s_waitcnt lgkmcnt(0)
    v_mfma_f32_16x16x32_bf16 v[64:67], v[36:39], v[52:55], v[64:67]
    s_nop 7
    v_add_u32 v196, v64, v65
    v_lshlrev_b32 v197, 3, v2
    v_add_u32 v92, s86, v197
    v_and_b32 v197, 0x38, v197
    v_add_u32 v197, s87, v197
    v_add_u32_dpp v196, v196, v196 row_ror:8 row_mask:0xf bank_mask:0xf
    s_nop 1
    v_add_u32_dpp v196, v196, v196 row_ror:4 row_mask:0xf bank_mask:0xf
    s_nop 1
    v_add_u32_dpp v196, v196, v196 row_ror:2 row_mask:0xf bank_mask:0xf
    s_nop 1
    v_add_u32_dpp v196, v196, v196 row_ror:1 row_mask:0xf bank_mask:0xf
    v_cmp_gt_u32 vcc, 16, v1
    v_add_u32 v196, v196, v4
    s_nop 0
    v_cndmask_b32 v92, v197, v92, vcc
    v_cndmask_b32 v82, v196, v64, vcc
    v_cndmask_b32 v83, v196, v65, vcc
    s_mov_b64 exec, 0xffffff
    s_mov_b32 s71, 8388608
    buffer_store_dwordx2 v[82:83], v92, s[40:43], s71 offen
    s_mov_b64 exec, -1
    s_mov_b32 s98, 0
    s_cmp_lt_u32 s98, 12
    s_cselect_b32 s4, 8388608, 0
    s_add_u32 s5, s3, 0
    s_lshl_b32 s6, s59, 13
    s_lshl_b32 s7, s5, 7
    s_add_u32 s6, s6, s7
    s_add_u32 s6, s6, s4
    s_add_u32 s6, s6, 1572864
    s_lshl_b32 s7, s59, 12
    s_lshl_b32 s5, s5, 6
    s_add_u32 s7, s7, s5
    s_add_u32 s7, s7, s4
    s_add_u32 s7, s7, 1835008
    buffer_load_dwordx4 v[16:19], v12, s[40:43], s6 offen sc1
    buffer_load_dword v24, v13, s[40:43], s7 offen sc1
    s_mov_b64 exec, 0xffffff
    buffer_store_dwordx2 v[82:83], v92, s[40:43], 0 offen sc1
    s_mov_b64 exec, -1
    s_cmp_eq_u32 s65, 0
    s_cbranch_scc1 Lnb3_42
    s_cmp_ge_u32 s3, 4
    s_cbranch_scc1 Lh_43
    s_waitcnt vmcnt(4)
    s_branch Lgb_45
Lgb_44:
    s_cmp_lt_u32 s98, 12
    s_cselect_b32 s4, 8388608, 0
    s_add_u32 s5, s3, 0
    s_lshl_b32 s6, s59, 13
    s_lshl_b32 s7, s5, 7
    s_add_u32 s6, s6, s7
    s_add_u32 s6, s6, s4
    s_add_u32 s6, s6, 2097152
    s_lshl_b32 s7, s59, 12
    s_lshl_b32 s5, s5, 6
    s_add_u32 s7, s7, s5
    s_add_u32 s7, s7, s4
    s_add_u32 s7, s7, 2359296
    buffer_load_dwordx4 v[100:103], v12, s[40:43], s6 offen sc1
    buffer_load_dword v108, v13, s[40:43], s7 offen sc1
    s_cmp_lt_u32 s98, 12
    s_cselect_b32 s4, 8388608, 0
    s_add_u32 s5, s3, 4
    s_lshl_b32 s6, s59, 13
    s_lshl_b32 s7, s5, 7
    s_add_u32 s6, s6, s7
    s_add_u32 s6, s6, s4
    s_add_u32 s6, s6, 2097152
    s_lshl_b32 s7, s59, 12
    s_lshl_b32 s5, s5, 6
    s_add_u32 s7, s7, s5
    s_add_u32 s7, s7, s4
    s_add_u32 s7, s7, 2359296
    buffer_load_dwordx4 v[104:107], v12, s[40:43], s6 offen sc1
    buffer_load_dword v109, v13, s[40:43], s7 offen sc1
    s_waitcnt vmcnt(0)
Lgb_45:
    v_add3_u32 v196, v100, v101, v102
    v_add_u32 v196, v196, v103
    v_add3_u32 v197, v104, v105, v106
    v_add_u32 v197, v197, v107
    v_add_u32_dpp v196, v196, v196 quad_perm:[1,0,3,2] row_mask:0xf bank_mask:0xf
    s_nop 0
    v_add_u32_dpp v197, v197, v197 quad_perm:[1,0,3,2] row_mask:0xf bank_mask:0xf
    v_add_u32_dpp v196, v196, v196 quad_perm:[2,3,0,1] row_mask:0xf bank_mask:0xf
    s_nop 0
    v_add_u32_dpp v197, v197, v197 quad_perm:[2,3,0,1] row_mask:0xf bank_mask:0xf
    v_add_u32_dpp v196, v196, v196 row_half_mirror row_mask:0xf bank_mask:0xf
    s_nop 0
    v_add_u32_dpp v197, v197, v197 row_half_mirror row_mask:0xf bank_mask:0xf
    v_add_u32 v196, v196, v4
    v_add_u32 v197, v197, v4
    v_xor_b32 v196, v196, v108
    v_xor_b32 v197, v197, v109
    v_or_b32 v196, v196, v197
    v_cmp_ne_u32 vcc, 0, v196
    s_cbranch_vccz Lok_46
    s_add_u32 s98, s98, 1
    s_sleep 1
    s_cmp_lt_u32 s98, 200000
    s_cbranch_scc1 Lgb_44
    s_or_b32 s99, s99, 8
Lok_46:
    v_add_f32_dpp v100, v100, v100 row_ror:8 row_mask:0xf bank_mask:0xf
    v_add_f32_dpp v101, v101, v101 row_ror:8 row_mask:0xf bank_mask:0xf
    v_add_f32_dpp v102, v102, v102 row_ror:8 row_mask:0xf bank_mask:0xf
    v_add_f32_dpp v103, v103, v103 row_ror:8 row_mask:0xf bank_mask:0xf
    v_add_f32_dpp v104, v104, v104 row_ror:8 row_mask:0xf bank_mask:0xf
    v_add_f32_dpp v105, v105, v105 row_ror:8 row_mask:0xf bank_mask:0xf
    v_add_f32_dpp v106, v106, v106 row_ror:8 row_mask:0xf bank_mask:0xf
    v_add_f32_dpp v107, v107, v107 row_ror:8 row_mask:0xf bank_mask:0xf
    v_mov_b32 v200, v100
    v_mov_b32 v201, v101
    v_mov_b32 v202, v102
    v_mov_b32 v203, v103
    v_mov_b32 v204, v104
    v_mov_b32 v205, v105
    v_mov_b32 v206, v106
    v_mov_b32 v207, v107
    v_permlane16_swap_b32 v100, v200
    v_permlane16_swap_b32 v101, v201
    v_permlane16_swap_b32 v102, v202
    v_permlane16_swap_b32 v103, v203
    v_permlane16_swap_b32 v104, v204
    v_permlane16_swap_b32 v105, v205
    v_permlane16_swap_b32 v106, v206
    v_permlane16_swap_b32 v107, v207
    v_add_f32 v100, v100, v200
    v_add_f32 v101, v101, v201
    v_add_f32 v102, v102, v202
    v_add_f32 v103, v103, v203
    v_add_f32 v104, v104, v204
    v_add_f32 v105, v105, v205
    v_add_f32 v106, v106, v206
    v_add_f32 v107, v107, v207
    v_mov_b32 v200, v100
    v_mov_b32 v201, v101
    v_mov_b32 v202, v102
    v_mov_b32 v203, v103
    v_mov_b32 v204, v104
    v_mov_b32 v205, v105
    v_mov_b32 v206, v106
    v_mov_b32 v207, v107
    v_permlane32_swap_b32 v100, v200
    v_permlane32_swap_b32 v101, v201
    v_permlane32_swap_b32 v102, v202
    v_permlane32_swap_b32 v103, v203
    v_permlane32_swap_b32 v104, v204
    v_permlane32_swap_b32 v105, v205
    v_permlane32_swap_b32 v106, v206
    v_permlane32_swap_b32 v107, v207
    v_add_f32 v100, v100, v200
    v_add_f32 v101, v101, v201
    v_add_f32 v102, v102, v202
    v_add_f32 v103, v103, v203
    v_add_f32 v104, v104, v204
    v_add_f32 v105, v105, v205
    v_add_f32 v106, v106, v206
    v_add_f32 v107, v107, v207
    v_cvt_pk_bf16_f32 v208, v100, v101
    v_and_b32 v101, s67, v208
    v_lshlrev_b32 v100, 16, v208
    v_cvt_pk_bf16_f32 v208, v102, v103
    v_and_b32 v103, s67, v208
    v_lshlrev_b32 v102, 16, v208
    v_cvt_pk_bf16_f32 v208, v104, v105
    v_and_b32 v105, s67, v208
    v_lshlrev_b32 v104, 16, v208
    v_cvt_pk_bf16_f32 v208, v106, v107
    v_and_b32 v107, s67, v208
    v_lshlrev_b32 v106, 16, v208
    s_mov_b32 s70, 0xbfb8aa3b
    v_mul_f32 v200, s70, v100
    v_mul_f32 v201, s70, v101
    v_mul_f32 v202, s70, v102
    v_mul_f32 v203, s70, v103
    v_exp_f32 v200, v200
    v_exp_f32 v201, v201
    v_exp_f32 v202, v202
    v_exp_f32 v203, v203
    v_add_f32 v200, 1.0, v200
    v_add_f32 v201, 1.0, v201
    v_add_f32 v202, 1.0, v202
    v_add_f32 v203, 1.0, v203
    v_rcp_f32 v200, v200
    v_rcp_f32 v201, v201
    v_rcp_f32 v202, v202
    v_rcp_f32 v203, v203
    v_mul_f32 v100, v100, v200
    v_mul_f32 v101, v101, v201
    v_mul_f32 v102, v102, v202
    v_mul_f32 v103, v103, v203
    v_cvt_pk_bf16_f32 v208, v100, v101
    v_and_b32 v101, s67, v208
    v_lshlrev_b32 v100, 16, v208
    v_cvt_pk_bf16_f32 v208, v102, v103
    v_and_b32 v103, s67, v208
    v_lshlrev_b32 v102, 16, v208
    v_mul_f32 v100, v100, v104
    v_mul_f32 v101, v101, v105
    v_mul_f32 v102, v102, v106
    v_mul_f32 v103, v103, v107
    v_cvt_pk_bf16_f32 v200, v100, v102
    v_cvt_pk_bf16_f32 v201, v101, v103
    s_lshl_b32 s69, s3, 5
    s_add_u32 s69, s69, 149120
    v_lshl_add_u32 v196, v1, 2, s69
    s_mov_b64 exec, 0xff
    ds_write_b32 v196, v200
    ds_write_b32 v196, v201 offset:128
    s_mov_b64 exec, -1
Lh_43:
    s_mov_b32 s98, 0
    s_and_b32 s84, s3, 3
    s_waitcnt vmcnt(4) lgkmcnt(0)
    s_barrier
    s_cmp_lt_u32 s98, 12
    s_cselect_b32 s4, 8388608, 0
    s_add_u32 s5, s3, 0
    s_lshl_b32 s6, s59, 13
    s_lshl_b32 s7, s5, 7
    s_add_u32 s6, s6, s7
    s_add_u32 s6, s6, s4
    s_add_u32 s6, s6, 1572864
    s_lshl_b32 s7, s59, 12
    s_lshl_b32 s5, s5, 6
    s_add_u32 s7, s7, s5
    s_add_u32 s7, s7, s4
    s_add_u32 s7, s7, 1835008
    buffer_load_dwordx4 v[20:23], v12, s[40:43], s6 offen sc1
    buffer_load_dword v25, v13, s[40:43], s7 offen sc1
    s_cmp_lt_u32 s3, 4
    s_cbranch_scc1 Lb2_47
    ds_read_b128 v[32:35], v118 offset:0
    ds_read_b64_tr_b16 v[48:49], v116 offset:0
    ds_read_b64_tr_b16 v[50:51], v117 offset:0
    ds_read_b128 v[36:39], v118 offset:64
    ds_read_b64_tr_b16 v[52:53], v116 offset:4096
    ds_read_b64_tr_b16 v[54:55], v117 offset:4096
    s_waitcnt lgkmcnt(3)
    v_mfma_f32_16x16x32_bf16 v[64:67], v[32:35], v[48:51], 0
    s_waitcnt lgkmcnt(0)
    v_mfma_f32_16x16x32_bf16 v[64:67], v[36:39], v[52:55], v[64:67]
    s_add_u32 s69, s64, 32
    s_lshl_b32 s70, s58, 6
    s_add_u32 s69, s69, s70
    s_lshl_b32 s69, s69, 2
    s_add_u32 s69, s69, s84
    s_lshl_b32 s68, s69, 7
    s_add_u32 s68, s68, 2621440
    s_lshl_b32 s70, s69, 6
    s_add_u32 s70, s70, 2883584
    v_add_u32 v196, v64, v65
    v_lshlrev_b32 v197, 3, v2
    v_add_u32 v81, s68, v197
    v_and_b32 v197, 0x38, v197
    v_add_u32 v197, s70, v197
    v_add_u32_dpp v196, v196, v196 row_ror:8 row_mask:0xf bank_mask:0xf
    s_nop 1
    v_add_u32_dpp v196, v196, v196 row_ror:4 row_mask:0xf bank_mask:0xf
    s_nop 1
    v_add_u32_dpp v196, v196, v196 row_ror:2 row_mask:0xf bank_mask:0xf
    s_nop 1
    v_add_u32_dpp v196, v196, v196 row_ror:1 row_mask:0xf bank_mask:0xf
    v_cmp_gt_u32 vcc, 16, v1
    v_add_u32 v196, v196, v4
    s_nop 0
    v_cndmask_b32 v81, v197, v81, vcc
    v_cndmask_b32 v68, v196, v64, vcc
    v_cndmask_b32 v69, v196, v65, vcc
    s_mov_b64 exec, 0xffffff
    buffer_store_dwordx2 v[68:69], v81, s[40:43], 0 offen sc1
    s_mov_b64 exec, -1
    s_lshl_b32 s69, s58, 9
    s_lshl_b32 s70, s84, 7
    s_add_u32 s69, s69, s70
    s_add_u32 s69, s69, 3702784
    s_mov_b64 exec, 1
    buffer_atomic_add v11, v5, s[40:43], s69 offen sc1
    s_mov_b64 exec, -1
    s_mov_b32 s78, 2
    s_waitcnt vmcnt(5)
    s_branch Lg4a_50
Lb2_47:
    s_mov_b32 s78, 0
    s_waitcnt vmcnt(3)
    s_branch Lg4a_50
Lnb3_42:
    s_mov_b32 s78, 0
    s_sleep 6
    s_cmp_lt_u32 s98, 12
    s_cselect_b32 s4, 8388608, 0
    s_add_u32 s5, s3, 0
    s_lshl_b32 s6, s59, 13
    s_lshl_b32 s7, s5, 7
    s_add_u32 s6, s6, s7
    s_add_u32 s6, s6, s4
    s_add_u32 s6, s6, 1572864
    s_lshl_b32 s7, s59, 12
    s_lshl_b32 s5, s5, 6
    s_add_u32 s7, s7, s5
    s_add_u32 s7, s7, s4
    s_add_u32 s7, s7, 1835008
    buffer_load_dwordx4 v[20:23], v12, s[40:43], s6 offen sc1
    buffer_load_dword v25, v13, s[40:43], s7 offen sc1
    s_waitcnt vmcnt(3)
Lg4a_50:
    v_add3_u32 v196, v16, v17, v18
    v_add_u32 v196, v196, v19
    s_nop 1
    v_add_u32_dpp v196, v196, v196 quad_perm:[1,0,3,2] row_mask:0xf bank_mask:0xf
    s_nop 1
    v_add_u32_dpp v196, v196, v196 quad_perm:[2,3,0,1] row_mask:0xf bank_mask:0xf
    s_nop 1
    v_add_u32_dpp v196, v196, v196 row_half_mirror row_mask:0xf bank_mask:0xf
    v_add_u32 v196, v196, v4
    v_xor_b32 v196, v196, v24
    v_cmp_ne_u32 vcc, 0, v196
    s_cbranch_vccz Lg4ok_51
    s_cmp_eq_u32 s78, 0
    s_cbranch_scc1 Lb0_52
    s_waitcnt vmcnt(2)
    s_branch Lb1_53
Lb0_52:
    s_waitcnt vmcnt(0)
Lb1_53:
    v_mov_b32 v16, v20
    v_mov_b32 v17, v21
    v_mov_b32 v18, v22
    v_mov_b32 v19, v23
    v_mov_b32 v24, v25
    s_branch Lg4c_49
Lg4_48:
    s_cmp_lt_u32 s98, 12
    s_cselect_b32 s4, 8388608, 0
    s_add_u32 s5, s3, 0
    s_lshl_b32 s6, s59, 13
    s_lshl_b32 s7, s5, 7
    s_add_u32 s6, s6, s7
    s_add_u32 s6, s6, s4
    s_add_u32 s6, s6, 1572864
    s_lshl_b32 s7, s59, 12
    s_lshl_b32 s5, s5, 6
    s_add_u32 s7, s7, s5
    s_add_u32 s7, s7, s4
    s_add_u32 s7, s7, 1835008
    buffer_load_dwordx4 v[16:19], v12, s[40:43], s6 offen sc1
    buffer_load_dword v24, v13, s[40:43], s7 offen sc1
    s_waitcnt vmcnt(0)
Lg4c_49:
    v_add3_u32 v196, v16, v17, v18
    v_add_u32 v196, v196, v19
    s_nop 1
    v_add_u32_dpp v196, v196, v196 quad_perm:[1,0,3,2] row_mask:0xf bank_mask:0xf
    s_nop 1
    v_add_u32_dpp v196, v196, v196 quad_perm:[2,3,0,1] row_mask:0xf bank_mask:0xf
    s_nop 1
    v_add_u32_dpp v196, v196, v196 row_half_mirror row_mask:0xf bank_mask:0xf
    v_add_u32 v196, v196, v4
    v_xor_b32 v196, v196, v24
    v_cmp_ne_u32 vcc, 0, v196
    s_cbranch_vccz Lok_54
    s_add_u32 s98, s98, 1
    s_sleep 1
    s_cmp_lt_u32 s98, 200000
    s_cbranch_scc1 Lg4_48
    s_or_b32 s99, s99, 16
Lok_54:
Lg4ok_51:
    s_and_b32 s84, s3, 3
    s_cmp_ge_u32 s3, 4
    s_cbranch_scc1 Lea_55
    s_lshl_b32 s69, s58, 9
    s_lshl_b32 s70, s84, 7
    s_add_u32 s69, s69, s70
    s_add_u32 s69, s69, 3702784
    s_mov_b64 exec, 1
    buffer_atomic_add v11, v5, s[40:43], s69 offen sc1
    s_mov_b64 exec, -1
Lea_55:
    v_add_f32_dpp v16, v16, v16 row_ror:8 row_mask:0xf bank_mask:0xf
    v_add_f32_dpp v17, v17, v17 row_ror:8 row_mask:0xf bank_mask:0xf
    v_add_f32_dpp v18, v18, v18 row_ror:8 row_mask:0xf bank_mask:0xf
    v_add_f32_dpp v19, v19, v19 row_ror:8 row_mask:0xf bank_mask:0xf
    v_mov_b32 v200, v16
    v_mov_b32 v201, v17
    v_mov_b32 v202, v18
    v_mov_b32 v203, v19
    v_permlane16_swap_b32 v16, v200
    v_permlane16_swap_b32 v17, v201
    v_permlane16_swap_b32 v18, v202
    v_permlane16_swap_b32 v19, v203
    v_add_f32 v16, v16, v200
    v_add_f32 v17, v17, v201
    v_add_f32 v18, v18, v202
    v_add_f32 v19, v19, v203
    v_mov_b32 v200, v16
    v_mov_b32 v201, v17
    v_mov_b32 v202, v18
    v_mov_b32 v203, v19
    v_permlane32_swap_b32 v16, v200
    v_permlane32_swap_b32 v17, v201
    v_permlane32_swap_b32 v18, v202
    v_permlane32_swap_b32 v19, v203
    v_add_f32 v16, v16, v200
    v_add_f32 v17, v17, v201
    v_add_f32 v18, v18, v202
    v_add_f32 v19, v19, v203
    v_cvt_pk_bf16_f32 v200, v16, v18
    v_cvt_pk_bf16_f32 v201, v17, v19
    s_lshl_b32 s69, s3, 5
    s_add_u32 s69, s69, 147968
    v_lshl_add_u32 v196, v1, 2, s69
    s_mov_b64 exec, 0xff
    ds_write_b32 v196, v200
    ds_write_b32 v196, v201 offset:256
    s_mov_b64 exec, -1
    s_waitcnt lgkmcnt(0)
    s_barrier
    s_cmp_ge_u32 s3, 4
    s_cbranch_scc1 Lo2_56
    ds_read_b128 v[32:35], v115 offset:0
    ds_read_b64_tr_b16 v[48:49], v113 offset:0
    ds_read_b64_tr_b16 v[50:51], v114 offset:0
    ds_read_b128 v[36:39], v115 offset:64
    ds_read_b64_tr_b16 v[52:53], v113 offset:4096
    ds_read_b64_tr_b16 v[54:55], v114 offset:4096
    ds_read_b128 v[40:43], v115 offset:128
    ds_read_b64_tr_b16 v[56:57], v113 offset:8192
    ds_read_b64_tr_b16 v[58:59], v114 offset:8192
    ds_read_b128 v[44:47], v115 offset:192
    ds_read_b64_tr_b16 v[60:61], v113 offset:12288
    ds_read_b64_tr_b16 v[62:63], v114 offset:12288
    s_waitcnt lgkmcnt(9)
    v_mfma_f32_16x16x32_bf16 v[64:67], v[32:35], v[48:51], 0
    s_waitcnt lgkmcnt(6)
    v_mfma_f32_16x16x32_bf16 v[64:67], v[36:39], v[52:55], v[64:67]
    s_waitcnt lgkmcnt(3)
    v_mfma_f32_16x16x32_bf16 v[64:67], v[40:43], v[56:59], v[64:67]
    s_waitcnt lgkmcnt(0)
    v_mfma_f32_16x16x32_bf16 v[64:67], v[44:47], v[60:63], v[64:67]
    s_mov_b32 s69, s59
    s_lshl_b32 s70, s58, 6
    s_add_u32 s69, s69, s70
    s_lshl_b32 s69, s69, 2
    s_add_u32 s69, s69, s84
    s_lshl_b32 s68, s69, 7
    s_add_u32 s68, s68, 2621440
    s_lshl_b32 s70, s69, 6
    s_add_u32 s70, s70, 2883584
    v_add_u32 v196, v64, v65
    v_lshlrev_b32 v197, 3, v2
    v_add_u32 v81, s68, v197
    v_and_b32 v197, 0x38, v197
    v_add_u32 v197, s70, v197
    v_add_u32_dpp v196, v196, v196 row_ror:8 row_mask:0xf bank_mask:0xf
    s_nop 1
    v_add_u32_dpp v196, v196, v196 row_ror:4 row_mask:0xf bank_mask:0xf
    s_nop 1
    v_add_u32_dpp v196, v196, v196 row_ror:2 row_mask:0xf bank_mask:0xf
    s_nop 1
    v_add_u32_dpp v196, v196, v196 row_ror:1 row_mask:0xf bank_mask:0xf
    v_cmp_gt_u32 vcc, 16, v1
    v_add_u32 v196, v196, v4
    s_nop 0
    v_cndmask_b32 v81, v197, v81, vcc
    v_cndmask_b32 v68, v196, v64, vcc
    v_cndmask_b32 v69, v196, v65, vcc
    s_mov_b64 exec, 0xffffff
    buffer_store_dwordx2 v[68:69], v81, s[40:43], 0 offen sc1
    s_mov_b64 exec, -1
Lo2_56:
    s_cmp_lg_u32 s57, 3
    s_cbranch_scc1 L_done
    s_cmp_ge_u32 s58, 4
    s_cbranch_scc1 L_done
    s_lshl_b32 s76, s56, 7
    s_lshl_b32 s70, s58, 5
    s_add_u32 s76, s76, s70
    v_lshlrev_b32 v9, 2, v1
    buffer_load_dword v40, v9, s[44:47], s76 offen
    buffer_load_dword v41, v9, s[44:47], s76 offen offset:1024
    v_lshrrev_b32 v216, 3, v1
    v_lshlrev_b32 v217, 9, v216
    v_and_b32 v218, 7, v1
    v_lshl_add_u32 v217, v218, 4, v217
    v_lshlrev_b32 v216, 8, v216
    s_lshl_b32 s69, s56, 6
    s_lshl_b32 s70, s3, 3
    s_add_u32 s69, s69, s70
    s_lshl_b32 s69, s69, 2
    s_add_u32 s69, s69, s58
    s_lshl_b32 s86, s69, 7
    s_add_u32 s86, s86, 2621440
    s_lshl_b32 s87, s69, 6
    s_add_u32 s87, s87, 2883584
    s_cmp_lg_u32 s3, 7
    s_cbranch_scc1 Lcw_57
    s_lshl_b32 s71, s56, 9
    s_lshl_b32 s70, s58, 7
    s_add_u32 s71, s71, s70
    s_add_u32 s71, s71, 3702784
    s_mov_b32 s98, 0
    v_mov_b32 v209, 54
    v_lshlrev_b32 v208, 7, v1
    s_mov_b64 exec, 1
    v_mov_b32 v210, 0
    buffer_atomic_or v210, v208, s[40:43], s71 offen sc0 sc1
    s_sleep 5
    v_mov_b32 v211, 0
    buffer_atomic_or v211, v208, s[40:43], s71 offen sc0 sc1
    s_sleep 5
    v_mov_b32 v212, 0
    buffer_atomic_or v212, v208, s[40:43], s71 offen sc0 sc1
    s_sleep 5
Lcwp_58:
    v_mov_b32 v213, 0
    buffer_atomic_or v213, v208, s[40:43], s71 offen sc0 sc1
    s_waitcnt vmcnt(3)
    v_cmp_ne_u32 vcc, v209, v210
    s_cbranch_vccz Lcwo_59
    s_sleep 5
    v_mov_b32 v210, 0
    buffer_atomic_or v210, v208, s[40:43], s71 offen sc0 sc1
    s_waitcnt vmcnt(3)
    v_cmp_ne_u32 vcc, v209, v211
    s_cbranch_vccz Lcwo_59
    s_sleep 5
    v_mov_b32 v211, 0
    buffer_atomic_or v211, v208, s[40:43], s71 offen sc0 sc1
    s_waitcnt vmcnt(3)
    v_cmp_ne_u32 vcc, v209, v212
    s_cbranch_vccz Lcwo_59
    s_sleep 5
    v_mov_b32 v212, 0
    buffer_atomic_or v212, v208, s[40:43], s71 offen sc0 sc1
    s_waitcnt vmcnt(3)
    v_cmp_ne_u32 vcc, v209, v213
    s_cbranch_vccz Lcwo_59
    s_sleep 5
    s_add_u32 s98, s98, 1
    s_cmp_lt_u32 s98, 200000
    s_cbranch_scc1 Lcwp_58
    s_or_b32 s99, s99, 128
Lcwo_59:
    s_mov_b64 exec, -1
Lcw_57:
    s_barrier
    s_cmp_ge_u32 s3, 7
    s_cbranch_scc1 Lf2_60
    s_cmp_eq_u32 s3, 6
    s_mov_b32 s96, -1
    s_cselect_b32 s97, 0xffff, -1
    v_mov_b32 v16, 0
    v_mov_b32 v17, 0
    v_mov_b32 v18, 0
    v_mov_b32 v19, 0
    s_mov_b32 s98, 0
    s_mov_b64 exec, s[96:97]
Lg5_61:
    buffer_load_dwordx4 v[16:19], v217, s[40:43], s86 offen sc1
    buffer_load_dword v24, v216, s[40:43], s87 offen sc1
    s_waitcnt vmcnt(0)
    v_add3_u32 v196, v16, v17, v18
    v_add_u32 v196, v196, v19
    s_nop 1
    v_add_u32_dpp v196, v196, v196 quad_perm:[1,0,3,2] row_mask:0xf bank_mask:0xf
    s_nop 1
    v_add_u32_dpp v196, v196, v196 quad_perm:[2,3,0,1] row_mask:0xf bank_mask:0xf
    s_nop 1
    v_add_u32_dpp v196, v196, v196 row_half_mirror row_mask:0xf bank_mask:0xf
    v_add_u32 v196, v196, v4
    v_xor_b32 v196, v196, v24
    v_cmp_ne_u32 vcc, 0, v196
    s_cbranch_vccz Lok_62
    s_add_u32 s98, s98, 1
    s_sleep 6
    s_cmp_lt_u32 s98, 200000
    s_cbranch_scc1 Lg5_61
    s_or_b32 s99, s99, 32
Lok_62:
    s_mov_b64 exec, -1
    v_add_f32_dpp v16, v16, v16 row_ror:8 row_mask:0xf bank_mask:0xf
    v_add_f32_dpp v17, v17, v17 row_ror:8 row_mask:0xf bank_mask:0xf
    v_add_f32_dpp v18, v18, v18 row_ror:8 row_mask:0xf bank_mask:0xf
    v_add_f32_dpp v19, v19, v19 row_ror:8 row_mask:0xf bank_mask:0xf
    v_mov_b32 v200, v16
    v_mov_b32 v201, v17
    v_mov_b32 v202, v18
    v_mov_b32 v203, v19
    v_permlane16_swap_b32 v16, v200
    v_permlane16_swap_b32 v17, v201
    v_permlane16_swap_b32 v18, v202
    v_permlane16_swap_b32 v19, v203
    v_add_f32 v16, v16, v200
    v_add_f32 v17, v17, v201
    v_add_f32 v18, v18, v202
    v_add_f32 v19, v19, v203
    v_mov_b32 v200, v16
    v_mov_b32 v201, v17
    v_mov_b32 v202, v18
    v_mov_b32 v203, v19
    v_permlane32_swap_b32 v16, v200
    v_permlane32_swap_b32 v17, v201
    v_permlane32_swap_b32 v18, v202
    v_permlane32_swap_b32 v19, v203
    v_add_f32 v16, v16, v200
    v_add_f32 v17, v17, v201
    v_add_f32 v18, v18, v202
    v_add_f32 v19, v19, v203
    s_lshl_b32 s69, s3, 7
    s_add_u32 s69, s69, 149632
    v_add_u32 v196, s69, v6
    s_mov_b64 exec, 0xff
    ds_write_b128 v196, v[16:19]
    s_mov_b64 exec, -1
Lf2_60:
    s_waitcnt lgkmcnt(0)
    s_barrier
    s_cmp_lg_u32 s3, 0
    s_cbranch_scc1 L_done
    v_add_u32 v197, 149632, v6
    s_mov_b64 exec, 0xff
    ds_read_b128 v[88:91], v197 offset:0
    ds_read_b128 v[92:95], v197 offset:128
    ds_read_b128 v[96:99], v197 offset:256
    ds_read_b128 v[100:103], v197 offset:384
    ds_read_b128 v[104:107], v197 offset:512
    ds_read_b128 v[108:111], v197 offset:640
    ds_read_b128 v[112:115], v197 offset:768
    v_lshlrev_b32 v200, 16, v40
    v_lshlrev_b32 v201, 16, v41
    v_and_b32 v202, s67, v40
    v_and_b32 v203, s67, v41
    s_waitcnt lgkmcnt(0)
    v_pk_add_f32 v[88:89], v[88:89], v[92:93]
    v_pk_add_f32 v[96:97], v[96:97], v[100:101]
    v_pk_add_f32 v[104:105], v[104:105], v[108:109]
    v_pk_add_f32 v[90:91], v[90:91], v[94:95]
    v_pk_add_f32 v[98:99], v[98:99], v[102:103]
    v_pk_add_f32 v[106:107], v[106:107], v[110:111]
    v_pk_add_f32 v[88:89], v[88:89], v[96:97]
    v_pk_add_f32 v[104:105], v[104:105], v[112:113]
    v_pk_add_f32 v[90:91], v[90:91], v[98:99]
    v_pk_add_f32 v[106:107], v[106:107], v[114:115]
    v_cvt_pk_bf16_f32 v198, v88, v89
    v_and_b32 v89, s67, v198
    v_lshlrev_b32 v88, 16, v198
    v_cvt_pk_bf16_f32 v198, v90, v91
    v_and_b32 v91, s67, v198
    v_lshlrev_b32 v90, 16, v198
    v_cvt_pk_bf16_f32 v198, v104, v105
    v_and_b32 v105, s67, v198
    v_lshlrev_b32 v104, 16, v198
    v_cvt_pk_bf16_f32 v198, v106, v107
    v_and_b32 v107, s67, v198
    v_lshlrev_b32 v106, 16, v198
    v_add_f32 v200, v200, v88
    v_add_f32 v201, v201, v89
    v_add_f32 v202, v202, v90
    v_add_f32 v203, v203, v91
    v_cvt_pk_bf16_f32 v198, v200, v201
    v_and_b32 v201, s67, v198
    v_lshlrev_b32 v200, 16, v198
    v_cvt_pk_bf16_f32 v198, v202, v203
    v_and_b32 v203, s67, v198
    v_lshlrev_b32 v202, 16, v198
    v_add_f32 v200, v200, v104
    v_add_f32 v201, v201, v105
    v_add_f32 v202, v202, v106
    v_add_f32 v203, v203, v107
    v_cvt_pk_bf16_f32 v198, v200, v202
    v_cvt_pk_bf16_f32 v199, v201, v203
    buffer_store_dword v198, v9, s[48:51], s76 offen
    buffer_store_dword v199, v9, s[48:51], s76 offen offset:1024
    s_or_b32 s69, s56, s58
    s_cmp_lg_u32 s69, 0
    s_cbranch_scc1 Lne_63
    s_mov_b64 exec, 0xf
    s_mov_b32 s69, 0
    v_mov_b32 v204, v4
    v_mov_b32 v205, v4
    v_mov_b32 v206, v4
    v_mov_b32 v207, v4
    buffer_store_dwordx4 v[204:207], v6, s[40:43], s69 offen sc1
Lne_63:
    s_mov_b64 exec, -1
L_done:
    s_cmp_eq_u32 s99, 0
    s_cbranch_scc1 Lnerr_64
    s_mov_b64 exec, 1
    v_mov_b32 v196, s99
    buffer_atomic_or v196, v5, s[52:55], 0 offen
    s_mov_b64 exec, -1
Lnerr_64:
L_exit:
    s_endpgm
    s_nop 0
    s_nop 0
    s_nop 0
    s_nop 0
    s_nop 0
    s_nop 0
    s_nop 0
    s_nop 0
    s_nop 0
    s_nop 0
    s_nop 0
    s_nop 0
    s_nop 0
    s_nop 0
    s_nop 0
    s_nop 0
    s_nop 0
    s_nop 0
    s_nop 0
    s_nop 0
    s_nop 0
    s_nop 0
    s_nop 0
    s_nop 0
    s_nop 0
    s_nop 0
    s_nop 0
    s_nop 0
    s_nop 0
    s_nop 0
    s_nop 0
    s_nop 0
    s_nop 0
    s_nop 0
    s_nop 0
    s_nop 0
    s_nop 0
    s_nop 0
    s_nop 0
    s_nop 0
    s_nop 0
    s_nop 0
    s_nop 0
    s_nop 0
    s_nop 0
    s_nop 0
    s_nop 0
    s_nop 0
    s_nop 0
    s_nop 0
    s_nop 0
    s_nop 0
    s_nop 0
    s_nop 0
    s_nop 0
    s_nop 0
    s_nop 0
    s_nop 0
    s_nop 0
    s_nop 0
    s_nop 0
    s_nop 0
    s_nop 0
    s_nop 0
    s_nop 0
    s_nop 0
    s_nop 0
    s_nop 0
    s_nop 0
    s_nop 0
    s_nop 0
    s_nop 0
    s_nop 0
    s_nop 0
    s_nop 0
    s_nop 0
    s_nop 0
    s_nop 0
    s_nop 0
    s_nop 0
    s_nop 0
    s_nop 0
    s_nop 0
    s_nop 0
    s_nop 0
    s_nop 0
    s_nop 0
    s_nop 0
    s_nop 0
    s_nop 0
    s_nop 0
    s_nop 0
    s_nop 0
    s_nop 0
    s_nop 0
    s_nop 0
    s_nop 0
    s_nop 0
    s_nop 0
    s_nop 0
    s_nop 0
    s_nop 0
    s_nop 0
    s_nop 0
    s_nop 0
    s_nop 0
    s_nop 0
    s_nop 0
    s_nop 0
    s_nop 0
    s_nop 0
    s_nop 0
    s_nop 0
    s_nop 0
    s_nop 0
    s_nop 0
    s_nop 0
    s_nop 0
    s_nop 0
    s_nop 0
    s_nop 0
    s_nop 0
    s_nop 0
    s_nop 0
    s_nop 0
    s_nop 0
    s_nop 0
    s_nop 0
    s_nop 0
    s_nop 0
    s_nop 0
    s_nop 0
    s_nop 0
    s_nop 0
    s_nop 0
    s_nop 0
    s_nop 0
    s_nop 0
    s_nop 0
    s_nop 0
    s_nop 0
    s_nop 0
    s_nop 0
    s_nop 0
    s_nop 0
    s_nop 0
    s_nop 0
    s_nop 0
    s_nop 0
    s_nop 0
    s_nop 0
    s_nop 0
    s_nop 0
    s_nop 0
    s_nop 0
    s_nop 0
    s_nop 0
    s_nop 0
    s_nop 0
    s_nop 0
    s_nop 0
    s_nop 0
    s_nop 0
    s_nop 0
    s_nop 0
    s_nop 0
    s_nop 0
    s_nop 0
    s_nop 0
    s_nop 0
    s_nop 0
    s_nop 0
    s_nop 0
    s_nop 0
    s_nop 0
    s_nop 0
    s_nop 0
    s_nop 0
    s_nop 0
    s_nop 0
    s_nop 0
    s_nop 0
    s_nop 0
    s_nop 0
    s_nop 0
    s_nop 0
    s_nop 0
    s_nop 0
    s_nop 0
    s_nop 0
    s_nop 0
    s_nop 0
    s_nop 0
    s_nop 0
    s_nop 0
    s_nop 0
    s_nop 0
    s_nop 0
    s_nop 0
    s_nop 0
    s_nop 0
    s_nop 0
    s_nop 0
    s_nop 0
    s_nop 0
    s_nop 0
    s_nop 0
    s_nop 0
    s_nop 0
    s_nop 0
    s_nop 0
    s_nop 0
    s_nop 0
    s_nop 0
    s_nop 0
    s_nop 0
    s_nop 0
    s_nop 0
    s_nop 0
    s_nop 0
    s_nop 0
    s_nop 0
    s_nop 0
    s_nop 0
    s_nop 0
    s_nop 0
    s_nop 0
    s_nop 0
    s_nop 0
    s_nop 0
    s_nop 0
    s_nop 0
    s_nop 0
    s_nop 0
    s_nop 0
    s_nop 0
    s_nop 0
    s_nop 0
    s_nop 0
    s_nop 0
    s_nop 0
    s_nop 0
    s_nop 0
    s_nop 0
    s_nop 0
    s_nop 0
    s_nop 0
    s_nop 0
    s_nop 0
    s_nop 0
    s_nop 0
    s_nop 0
    s_nop 0
    s_nop 0
    s_nop 0
    s_nop 0
    s_endpgm
.section .rodata,"a"
.p2align 6
.amdhsa_kernel parallel_sum__compressed_kv_cla__glu_gated_swiglu__decode_kernel
  .amdhsa_next_free_vgpr 256
  .amdhsa_next_free_sgpr 102
  .amdhsa_accum_offset 256
  .amdhsa_group_segment_fixed_size 0
  .amdhsa_kernarg_size 104
  .amdhsa_user_sgpr_count 2
  .amdhsa_user_sgpr_kernarg_segment_ptr 1
  .amdhsa_system_sgpr_workgroup_id_x 1
.end_amdhsa_kernel
```
